```python
import torch

def _softmax(x, axis=-1):
    return torch.softmax(x, dim=axis)
def _gelu(x):
    return torch.nn.functional.gelu(x, approximate="tanh")
def _silu(x):
    return torch.nn.functional.silu(x)
def _sigmoid(x):
    return torch.sigmoid(x)
def _layernorm(x, axis=-1, eps=1e-5):
    m = x.mean(dim=axis, keepdim=True)
    v = x.var(dim=axis, keepdim=True, unbiased=False)
    return (x - m) / torch.sqrt(v + eps)
def _scatter_add(tgt, idx, src, axis=0):
    return tgt.clone().index_add_(axis, idx, src)
def _segment_sum(src, seg, n):
    out = torch.zeros((n,) + src.shape[1:], dtype=src.dtype)
    return out.index_add_(0, seg, src)
def _pad(x, pw):
    flat = tuple(v for pair in reversed(pw) for v in pair)
    return torch.nn.functional.pad(x, flat)

kernel_name = 'interleave_layers__gqa_block_cached__sliding_block_cached__decode'

def setup_inputs():

    _w = (lambda a: (lambda t: t.to(torch.bfloat16) if t.is_floating_point() else t)(torch.as_tensor(a)))
    def _A_setup():
        B, Sq, D = 2, 1, 640
        Hq, Hkv, Sk, Dh = 32, 32, 4096, 192
        assert Hq % Hkv == 0, (Hq, Hkv)
        return {
            "x": _w((lambda *s: torch.randn(*s, dtype=torch.bfloat16) * 0.1)(B, Sq, D)),
            "k_cache": _w((lambda *s: torch.randn(*s, dtype=torch.bfloat16) * 0.8)(B, Hkv, Sk, Dh)),
            "v_cache": _w((lambda *s: torch.randn(*s, dtype=torch.bfloat16) * 3.2)(B, Hkv, Sk, Dh)),
            "wq": _w((lambda *s: torch.randn(*s, dtype=torch.bfloat16) * 0.8)(D, Hq * Dh) * (D ** -0.5)),
            "wo": _w((lambda *s: torch.randn(*s, dtype=torch.bfloat16) * 3.2)(Hq * Dh, D) * ((Hq * Dh) ** -0.5)),
        }
    _A_in = _A_setup()

    def _B_setup():
        B, Sq, D = 2, 1, 640
        Hq, Hkv, Sk, Dh = 32, 32, 4096, 192
        assert Hq % Hkv == 0, (Hq, Hkv)
        return {
            "x": _w((lambda *s: torch.randn(*s, dtype=torch.bfloat16) * 0.1)(B, Sq, D)),
            "k_cache": _w((lambda *s: torch.randn(*s, dtype=torch.bfloat16) * 1.6)(B, Hkv, Sk, Dh)),
            "v_cache": _w((lambda *s: torch.randn(*s, dtype=torch.bfloat16) * 1.6)(B, Hkv, Sk, Dh)),
            "wq": _w((lambda *s: torch.randn(*s, dtype=torch.bfloat16) * 1.6)(D, Hq * Dh) * (D ** -0.5)),
            "wo": _w((lambda *s: torch.randn(*s, dtype=torch.bfloat16) * 1.6)(Hq * Dh, D) * ((Hq * Dh) ** -0.5)),
        }
    _B_in = _B_setup()

    return {
        "A_x": _A_in["x"],
        "A_k_cache": _A_in["k_cache"],
        "A_v_cache": _A_in["v_cache"],
        "A_wq": _A_in["wq"],
        "A_wo": _A_in["wo"],
        "B_x": _B_in["x"],
        "B_k_cache": _B_in["k_cache"],
        "B_v_cache": _B_in["v_cache"],
        "B_wq": _B_in["wq"],
        "B_wo": _B_in["wo"],
    }

def reference(A_x, A_k_cache, A_v_cache, A_wq, A_wo, B_x, B_k_cache, B_v_cache, B_wq, B_wo):
    def _A_ref(x, k_cache, v_cache, wq, wo):
        B, Sq, D = x.shape
        Hq, Dh = 32, 192
        Hkv = k_cache.shape[1]
        rep = Hq // Hkv
        q = (lambda x, *d: x.permute(*d))((x @ wq).reshape(B, Sq, Hq, Dh), 0, 2, 1, 3)
        k = (lambda x, n, axis: torch.repeat_interleave(x, n, dim=axis))(k_cache, rep, axis=1)
        v = (lambda x, n, axis: torch.repeat_interleave(x, n, dim=axis))(v_cache, rep, axis=1)
        scores = torch.einsum("bhqd,bhkd->bhqk", q, k) * (Dh ** -0.5)
        p = _softmax(scores, axis=-1)
        o = torch.einsum("bhqk,bhkd->bhqd", p, v)
        return (lambda x, *d: x.permute(*d))(o, 0, 2, 1, 3).reshape(B, Sq, Hq * Dh) @ wo

    def _B_ref(x, k_cache, v_cache, wq, wo):
        B, Sq, D = x.shape
        Hq, Dh = 32, 192
        Hkv, Sk = k_cache.shape[1], k_cache.shape[2]
        W = min(4096, max(256, Sk // 4))
        rep = Hq // Hkv
        q = (lambda x, *d: x.permute(*d))((x @ wq).reshape(B, Sq, Hq, Dh), 0, 2, 1, 3)
        k = (lambda x, n, axis: torch.repeat_interleave(x, n, dim=axis))(k_cache[:, :, Sk - W:, :], rep, axis=1)
        v = (lambda x, n, axis: torch.repeat_interleave(x, n, dim=axis))(v_cache[:, :, Sk - W:, :], rep, axis=1)
        scores = torch.einsum("bhqd,bhkd->bhqk", q, k) * (Dh ** -0.5)
        p = _softmax(scores, axis=-1)
        o = torch.einsum("bhqk,bhkd->bhqd", p, v)
        return (lambda x, *d: x.permute(*d))(o, 0, 2, 1, 3).reshape(B, Sq, Hq * Dh) @ wo

    x = A_x
    x = x + _A_ref(_layernorm(x, axis=-1), A_k_cache, A_v_cache, A_wq, A_wo)
    x = x + _B_ref(_layernorm(x, axis=-1), B_k_cache, B_v_cache, B_wq, B_wo)
    x = x + _A_ref(_layernorm(x, axis=-1), A_k_cache, A_v_cache, A_wq, A_wo)
    x = x + _B_ref(_layernorm(x, axis=-1), B_k_cache, B_v_cache, B_wq, B_wo)
    return x
```

```asm
; @launch grid=(256,1,1) block=(256,1,1) lds=163840
.amdgcn_target "amdgcn-amd-amdhsa--gfx950"
.text
.globl interleave_layers__gqa_block_cached__sliding_block_cached__decode_kernel
.p2align 8
.type interleave_layers__gqa_block_cached__sliding_block_cached__decode_kernel,@function
interleave_layers__gqa_block_cached__sliding_block_cached__decode_kernel:
    s_load_dwordx16 s[64:79], s[0:1], 0
    s_load_dwordx8 s[80:87], s[0:1], 64
    s_load_dwordx2 s[88:89], s[0:1], 96
    s_cmp_ge_u32 s2, 256
    s_cbranch_scc1 Lexit
    v_lshrrev_b32 v10, 6, v0
    v_lshlrev_b32 v0, 4, v0
    v_readfirstlane_b32 s4, v10
    v_and_b32 v0, 0x3f0, v0
    s_and_b32 s3, s2, 7
    s_lshl_b32 s3, s3, 5
    s_lshr_b32 s60, s2, 3
    s_add_u32 s3, s3, s60
    s_lshr_b32 s52, s3, 3
    s_bfe_u32 s53, s3, 0x10002
    s_and_b32 s54, s3, 3
    v_bfe_u32 v10, v0, 4, 3
    v_lshrrev_b32 v11, 7, v0
    v_mul_u32_u24 v1, 384, v10
    v_lshl_add_u32 v1, v11, 4, v1
    s_lshl_b32 s60, s53, 5
    s_add_u32 s60, s60, s52
    s_mul_i32 s60, s60, 1572864
    s_mul_i32 s61, s54, 393216
    s_add_u32 s61, s61, s60
    s_mul_i32 s57, s4, 98304
    s_mov_b32 s10, 393216
    s_mov_b32 s11, 0x20000
    s_waitcnt lgkmcnt(0)
    s_add_u32 s8, s66, s61
    s_addc_u32 s9, s67, 0
    buffer_load_dwordx4 a[0:3], v1, s[8:11], s57 offen offset:0 nt
    buffer_load_dwordx4 a[4:7], v1, s[8:11], s57 offen offset:128 nt
    buffer_load_dwordx4 a[8:11], v1, s[8:11], s57 offen offset:256 nt
    buffer_load_dwordx4 a[12:15], v1, s[8:11], s57 offen offset:3072 nt
    buffer_load_dwordx4 a[16:19], v1, s[8:11], s57 offen offset:3200 nt
    buffer_load_dwordx4 a[20:23], v1, s[8:11], s57 offen offset:3328 nt
    s_mul_i32 s62, s54, 98304
    s_add_u32 s62, s62, s60
    s_add_u32 s62, s62, 1179648
    s_and_b32 s60, s3, 31
    s_and_b32 s63, s60, 1
    s_cmp_lt_u32 s60, 30
    s_cselect_b32 s7, s63, 2
    s_min_u32 s60, s60, 29
    s_lshr_b32 s60, s60, 1
    s_mul_i32 s55, s60, 13108
    s_lshr_b32 s55, s55, 16
    s_mul_i32 s63, s55, 5
    s_sub_u32 s94, s60, s63
    s_lshr_b32 s60, s3, 5
    s_mul_i32 s60, s60, 3
    s_add_u32 s55, s55, s60
    s_lshr_b32 s60, s4, 1
    s_lshl_b32 s56, s94, 1
    s_add_u32 s56, s56, s60
    s_mul_i32 s58, s4, 24576
    v_mul_u32_u24 v2, 3072, v11
    v_lshl_add_u32 v2, v10, 4, v2
    s_lshl_b32 s60, s4, 10
    v_add_u32 v3, s60, v0
    v_mov_b32 v12, -1
    v_mov_b32 v13, -1
    v_mov_b32 v14, -1
    v_mov_b32 v15, -1
    v_mov_b32 v57, 0
    v_mov_b32 v58, 0
    v_mov_b32 v64, 0
    v_mov_b32 v66, 0
    v_mov_b32 v67, 0
    s_mul_i32 s90, s55, 327680
    s_lshl_b32 s63, s94, 8
    s_add_u32 s90, s90, s63
    s_mul_i32 s91, s94, 1572864
    s_lshl_b32 s63, s55, 9
    s_add_u32 s91, s91, s63
    s_mov_b32 s92, 1561088
    s_cmp_eq_u32 s7, 0
    s_cselect_b32 s90, s90, s91
    s_cselect_b32 s92, 326656, s92
    s_cselect_b64 s[70:71], s[72:73], s[70:71]
    s_cselect_b64 s[80:81], s[82:83], s[80:81]
    s_add_u32 s24, s70, s90
    s_addc_u32 s25, s71, 0
    s_mov_b32 s26, s92
    s_mov_b32 s27, 0x20000
    s_add_u32 s28, s80, s90
    s_addc_u32 s29, s81, 0
    s_mov_b32 s30, s92
    s_mov_b32 s31, 0x20000
    s_mov_b32 s40, s88
    s_mov_b32 s41, s89
    s_mov_b32 s42, 1441792
    s_mov_b32 s43, 0x20000
    s_mov_b32 s48, s64
    s_mov_b32 s49, s65
    s_mov_b32 s50, 2560
    s_mov_b32 s51, 0x20000
    s_add_u32 s12, s68, s61
    s_addc_u32 s13, s69, 0
    s_mov_b32 s14, 393216
    s_mov_b32 s15, 0x20000
    s_add_u32 s16, s76, s62
    s_addc_u32 s17, s77, 0
    s_mov_b32 s18, 98304
    s_mov_b32 s19, 0x20000
    s_add_u32 s20, s78, s62
    s_addc_u32 s21, s79, 0
    s_mov_b32 s22, 98304
    s_mov_b32 s23, 0x20000
    s_mov_b32 s44, s84
    s_mov_b32 s45, s85
    s_mov_b32 s46, 2560
    s_mov_b32 s47, 0x20000
    s_mov_b32 s36, s86
    s_mov_b32 s37, s87
    s_mov_b32 s38, 256
    s_mov_b32 s39, 0x20000
    s_mov_b32 s6, 0
    s_mov_b32 s34, 0
    s_mov_b32 s35, 0
    s_mov_b32 s84, 1037384597
    s_lshr_b32 s85, s3, 5
    s_and_b32 s75, s4, 1
    s_lshl_b32 s78, s56, 1
    s_add_u32 s78, s78, s75
    s_mov_b32 s79, s94
    s_lshl_b32 s80, s4, 10
    s_mov_b32 s76, 0
    s_mov_b32 s77, 0
    s_cmp_eq_u32 s7, 1
    s_cbranch_scc1 LiQ
    s_cmp_eq_u32 s7, 2
    s_cbranch_scc1 LiN
    v_lshrrev_b32 v17, 7, v0
    v_mul_u32_u24 v17, 1280, v17
    v_and_b32 v16, 0x70, v0
    v_or_b32 v16, v16, v17
    v_bfe_u32 v17, v0, 8, 1
    v_lshlrev_b32 v17, 5, v17
    v_xor_b32 v16, v16, v17
    v_xor_b32 v17, 64, v16
    s_lshr_b32 s64, s4, 1
    s_lshl_b32 s64, s64, 7
    s_mul_i32 s65, s75, 163840
    s_add_u32 s64, s64, s65
    s_lshl_b32 m0, s4, 14
    s_nop 0
    buffer_load_dwordx4 v16, s[24:27], s64 offen nt lds
    s_waitcnt vmcnt(8)
    s_add_u32 m0, m0, 1024
    s_add_u32 s64, s64, 10240
    buffer_load_dwordx4 v17, s[24:27], s64 offen nt lds
    s_waitcnt vmcnt(8)
    s_add_u32 m0, m0, 1024
    s_add_u32 s64, s64, 10240
    buffer_load_dwordx4 v16, s[24:27], s64 offen nt lds
    s_waitcnt vmcnt(8)
    s_add_u32 m0, m0, 1024
    s_add_u32 s64, s64, 10240
    buffer_load_dwordx4 v17, s[24:27], s64 offen nt lds
    s_waitcnt vmcnt(8)
    s_add_u32 m0, m0, 1024
    s_add_u32 s64, s64, 10240
    buffer_load_dwordx4 v16, s[24:27], s64 offen nt lds
    s_waitcnt vmcnt(8)
    s_add_u32 m0, m0, 1024
    s_add_u32 s64, s64, 10240
    buffer_load_dwordx4 v17, s[24:27], s64 offen nt lds
    s_waitcnt vmcnt(8)
    s_add_u32 m0, m0, 1024
    s_add_u32 s64, s64, 10240
    buffer_load_dwordx4 v16, s[24:27], s64 offen nt lds
    s_waitcnt vmcnt(8)
    s_add_u32 m0, m0, 1024
    s_add_u32 s64, s64, 10240
    buffer_load_dwordx4 v17, s[24:27], s64 offen nt lds
    s_waitcnt vmcnt(8)
    s_add_u32 m0, m0, 1024
    s_add_u32 s64, s64, 10240
    buffer_load_dwordx4 v16, s[24:27], s64 offen nt lds
    s_waitcnt vmcnt(8)
    s_add_u32 m0, m0, 1024
    s_add_u32 s64, s64, 10240
    buffer_load_dwordx4 v17, s[24:27], s64 offen nt lds
    s_waitcnt vmcnt(8)
    s_add_u32 m0, m0, 1024
    s_add_u32 s64, s64, 10240
    buffer_load_dwordx4 v16, s[24:27], s64 offen nt lds
    s_waitcnt vmcnt(8)
    s_add_u32 m0, m0, 1024
    s_add_u32 s64, s64, 10240
    buffer_load_dwordx4 v17, s[24:27], s64 offen nt lds
    s_waitcnt vmcnt(8)
    s_add_u32 m0, m0, 1024
    s_add_u32 s64, s64, 10240
    buffer_load_dwordx4 v16, s[24:27], s64 offen nt lds
    s_waitcnt vmcnt(8)
    s_add_u32 m0, m0, 1024
    s_add_u32 s64, s64, 10240
    buffer_load_dwordx4 v17, s[24:27], s64 offen nt lds
    s_waitcnt vmcnt(8)
    s_add_u32 m0, m0, 1024
    s_add_u32 s64, s64, 10240
    buffer_load_dwordx4 v16, s[24:27], s64 offen nt lds
    s_waitcnt vmcnt(8)
    s_add_u32 m0, m0, 1024
    s_add_u32 s64, s64, 10240
    buffer_load_dwordx4 v17, s[24:27], s64 offen nt lds
    s_waitcnt vmcnt(8)
    s_mul_i32 s60, s78, 24
    s_add_u32 s60, s60, s55
    s_lshl_b32 s60, s60, 8
    s_add_u32 s60, s60, 200704
    s_add_u32 s61, s60, 122880
    s_mov_b64 exec, 0xffff
    buffer_store_dwordx4 v[12:15], v0, s[40:43], s60 offen sc1
    buffer_store_dwordx4 v[12:15], v0, s[40:43], s61 offen sc1
    s_mov_b64 exec, -1
    s_branch LiN
LiQ:
    v_bfe_u32 v18, v0, 7, 1
    v_lshrrev_b32 v19, 8, v0
    v_lshl_or_b32 v18, v18, 2, v19
    v_bfe_u32 v19, v0, 4, 3
    v_lshl_or_b32 v18, v18, 3, v19
    v_lshlrev_b32 v18, 1, v18
    s_mul_i32 s60, s75, 1280
    s_lshl_b32 s61, s56, 7
    s_add_u32 s60, s60, s61
    buffer_load_ushort v8, v18, s[48:51], s60 offen
    v_lshrrev_b32 v17, 9, v0
    v_mul_u32_u24 v17, 12320, v17
    v_and_b32 v16, 0x1f0, v0
    v_xor_b32 v16, v16, v17
    v_xor_b32 v17, 64, v16
    s_mul_i32 s64, s4, 393216
    s_lshl_b32 m0, s4, 14
    s_nop 0
    buffer_load_dwordx4 v16, s[24:27], s64 offen nt lds
    s_waitcnt vmcnt(8)
    s_add_u32 m0, m0, 1024
    s_add_u32 s64, s64, 24576
    buffer_load_dwordx4 v17, s[24:27], s64 offen nt lds
    s_waitcnt vmcnt(8)
    s_add_u32 m0, m0, 1024
    s_add_u32 s64, s64, 24576
    buffer_load_dwordx4 v16, s[24:27], s64 offen nt lds
    s_waitcnt vmcnt(8)
    s_add_u32 m0, m0, 1024
    s_add_u32 s64, s64, 24576
    buffer_load_dwordx4 v17, s[24:27], s64 offen nt lds
    s_waitcnt vmcnt(8)
    s_add_u32 m0, m0, 1024
    s_add_u32 s64, s64, 24576
    v_xor_b32 v16, 128, v16
    v_xor_b32 v17, 128, v17
    buffer_load_dwordx4 v16, s[24:27], s64 offen nt lds
    s_waitcnt vmcnt(8)
    s_add_u32 m0, m0, 1024
    s_add_u32 s64, s64, 24576
    buffer_load_dwordx4 v17, s[24:27], s64 offen nt lds
    s_waitcnt vmcnt(8)
    s_add_u32 m0, m0, 1024
    s_add_u32 s64, s64, 24576
    buffer_load_dwordx4 v16, s[24:27], s64 offen nt lds
    s_waitcnt vmcnt(8)
    s_add_u32 m0, m0, 1024
    s_add_u32 s64, s64, 24576
    buffer_load_dwordx4 v17, s[24:27], s64 offen nt lds
    s_waitcnt vmcnt(8)
    s_add_u32 m0, m0, 1024
    s_add_u32 s64, s64, 24576
    v_xor_b32 v16, 128, v16
    v_xor_b32 v17, 128, v17
    buffer_load_dwordx4 v16, s[24:27], s64 offen nt lds
    s_waitcnt vmcnt(8)
    s_add_u32 m0, m0, 1024
    s_add_u32 s64, s64, 24576
    buffer_load_dwordx4 v17, s[24:27], s64 offen nt lds
    s_waitcnt vmcnt(8)
    s_add_u32 m0, m0, 1024
    s_add_u32 s64, s64, 24576
    buffer_load_dwordx4 v16, s[24:27], s64 offen nt lds
    s_waitcnt vmcnt(8)
    s_add_u32 m0, m0, 1024
    s_add_u32 s64, s64, 24576
    buffer_load_dwordx4 v17, s[24:27], s64 offen nt lds
    s_waitcnt vmcnt(8)
    s_add_u32 m0, m0, 1024
    s_add_u32 s64, s64, 24576
    v_xor_b32 v16, 128, v16
    v_xor_b32 v17, 128, v17
    buffer_load_dwordx4 v16, s[24:27], s64 offen nt lds
    s_waitcnt vmcnt(8)
    s_add_u32 m0, m0, 1024
    s_add_u32 s64, s64, 24576
    buffer_load_dwordx4 v17, s[24:27], s64 offen nt lds
    s_waitcnt vmcnt(8)
    s_add_u32 m0, m0, 1024
    s_add_u32 s64, s64, 24576
    buffer_load_dwordx4 v16, s[24:27], s64 offen nt lds
    s_waitcnt vmcnt(8)
    s_add_u32 m0, m0, 1024
    s_add_u32 s64, s64, 24576
    buffer_load_dwordx4 v17, s[24:27], s64 offen nt lds
    s_waitcnt vmcnt(8)
    v_lshrrev_b32 v64, 8, v0
    v_bfe_u32 v65, v0, 6, 2
    v_lshlrev_b32 v60, 12, v64
    v_lshl_or_b32 v60, v65, 9, v60
    v_and_b32 v66, 1, v64
    v_lshl_or_b32 v65, v66, 2, v65
    v_lshl_or_b32 v60, v65, 5, v60
    v_bfe_u32 v65, v0, 4, 2
    v_lshl_or_b32 v60, v65, 3, v60
    s_lshl_b32 s65, s4, 7
    v_xor_b32 v60, s65, v60
    v_xor_b32 v61, 32, v60
    v_xor_b32 v62, 64, v60
    v_xor_b32 v63, 96, v60
    v_mul_u32_u24 v66, 27648, v64
    v_and_b32 v67, 0xf0, v0
    v_add_u32 v66, v66, v67
    v_bfe_u32 v67, v0, 6, 2
    v_min_u32 v67, 2, v67
    v_lshlrev_b32 v67, 8, v67
    v_lshl_add_u32 v64, v64, 4, v67
    v_add_u32 v64, 161792, v64
    v_bfe_u32 v65, v0, 7, 1
    v_lshrrev_b32 v67, 8, v0
    v_lshl_or_b32 v65, v65, 2, v67
    v_bfe_u32 v67, v0, 4, 3
    v_lshl_or_b32 v65, v65, 3, v67
    s_lshl_b32 s65, s75, 8
    s_lshr_b32 s66, s4, 1
    s_lshl_b32 s66, s66, 7
    s_add_u32 s65, s65, s66
    s_add_u32 s65, s65, 161792
    v_lshl_add_u32 v65, v65, 1, s65
    v_lshrrev_b32 v67, 9, v0
    v_bfe_u32 v59, v0, 4, 1
    v_lshlrev_b32 v67, 2, v67
    v_lshl_or_b32 v67, v59, 3, v67
    ds_write_b16 v65, v8
    v_lshlrev_b32 v8, 16, v8
    v_lshrrev_b32 v16, 2, v0
    v_add_u32 v16, 162304, v16
    v_mov_b32 v17, 0x3f803f80
    ds_write_b32 v16, v17
LiN:
    s_cmp_lg_u32 s4, 2
    s_cbranch_scc1 Ls_1
    s_lshl_b32 s60, s54, 1
    s_add_u32 s60, s60, s53
    s_mul_i32 s60, s60, 24576
    s_mul_i32 s61, s52, 768
    s_add_u32 s60, s60, s61
    s_mov_b32 exec_lo, -1
    s_mov_b32 exec_hi, 0xffff
    buffer_store_dwordx4 v[12:15], v0, s[40:43], s60 offen sc1
    s_mov_b64 exec, -1
    s_nop 0
Ls_1:
    s_cmp_lg_u32 s4, 3
    s_cbranch_scc1 Ls_2
    v_mov_b32 v16, 162944
    v_mov_b32 v20, 0xff800000
    v_mov_b32 v21, 0xff800000
    v_mov_b32 v22, 0xff800000
    v_mov_b32 v23, 0xff800000
    ds_write_b128 v16, v[20:23]
    s_and_b32 s60, s3, 31
    s_cbranch_scc1 Ls_3
    s_lshl_b32 s60, s85, 7
    s_add_u32 s60, s60, 196608
    s_mov_b64 exec, 0xff
    buffer_store_dwordx4 v[12:15], v0, s[40:43], s60 offen sc1
    s_mov_b64 exec, -1
    s_nop 0
Ls_3:
Ls_2:
    v_bfe_u32 v16, v0, 7, 1
    v_mul_u32_u24 v16, 0x202, v16
    v_add_u32 v16, 0x0100, v16
    v_or_b32 v17, 0x0c0c0000, v16
    v_lshlrev_b32 v16, 16, v16
    v_or_b32 v16, 0x0c0c, v16
    v_bfe_u32 v18, v0, 4, 1
    v_cmp_eq_u32 vcc, 1, v18
    s_nop 1
    v_cndmask_b32 v16, v17, v16, vcc
    v_bfe_u32 v18, v0, 5, 2
    v_mov_b32 v17, 0x0c0c0c0c
    v_cmp_eq_u32 vcc, 0, v18
    s_nop 1
    v_cndmask_b32 v4, v17, v16, vcc
    v_cmp_eq_u32 vcc, 1, v18
    s_nop 1
    v_cndmask_b32 v5, v17, v16, vcc
    v_cmp_eq_u32 vcc, 2, v18
    s_nop 1
    v_cndmask_b32 v6, v17, v16, vcc
    v_cmp_eq_u32 vcc, 3, v18
    s_nop 1
    v_cndmask_b32 v7, v17, v16, vcc
    s_add_u32 s60, s57, 6144
    buffer_load_dwordx4 a[24:27], v1, s[8:11], s60 offen offset:0 nt
    s_waitcnt vmcnt(6)
    buffer_load_dwordx4 a[28:31], v1, s[8:11], s60 offen offset:128 nt
    s_waitcnt vmcnt(6)
    buffer_load_dwordx4 a[32:35], v1, s[8:11], s60 offen offset:256 nt
    s_waitcnt vmcnt(6)
    buffer_load_dwordx4 a[36:39], v1, s[8:11], s60 offen offset:3072 nt
    s_waitcnt vmcnt(6)
    buffer_load_dwordx4 a[40:43], v1, s[8:11], s60 offen offset:3200 nt
    s_waitcnt vmcnt(6)
    buffer_load_dwordx4 a[44:47], v1, s[8:11], s60 offen offset:3328 nt
    s_waitcnt vmcnt(6)
    s_waitcnt lgkmcnt(0)
    s_barrier
    s_add_u32 s60, s57, 12288
    buffer_load_dwordx4 a[48:51], v1, s[8:11], s60 offen offset:0 nt
    buffer_load_dwordx4 a[52:55], v1, s[8:11], s60 offen offset:128 nt
    buffer_load_dwordx4 a[56:59], v1, s[8:11], s60 offen offset:256 nt
    buffer_load_dwordx4 a[60:63], v1, s[8:11], s60 offen offset:3072 nt
    buffer_load_dwordx4 a[64:67], v1, s[8:11], s60 offen offset:3200 nt
    buffer_load_dwordx4 a[68:71], v1, s[8:11], s60 offen offset:3328 nt
    s_cmp_lg_u32 s7, 1
    s_cbranch_scc1 Ls_4
    ds_read_b64_tr_b16 v[36:37], v60 offset:0
    ds_read_b64_tr_b16 v[38:39], v60 offset:2048
    ds_read_b64_tr_b16 v[40:41], v61 offset:0
    ds_read_b64_tr_b16 v[42:43], v61 offset:2048
    ds_read_b64_tr_b16 v[44:45], v62 offset:0
    ds_read_b64_tr_b16 v[46:47], v62 offset:2048
    ds_read_b64_tr_b16 v[48:49], v63 offset:0
    ds_read_b64_tr_b16 v[50:51], v63 offset:2048
    ds_read_b64_tr_b16 v[52:53], v60 offset:16384
    ds_read_b64_tr_b16 v[54:55], v60 offset:18432
    v_mov_b32 v56, v8
    s_nop 1
    s_call_b64 s[72:73], Lqproj
Ls_4:
    s_add_u32 s60, s57, 18432
    buffer_load_dwordx4 a[72:75], v1, s[8:11], s60 offen offset:0 nt
    s_waitcnt vmcnt(6)
    buffer_load_dwordx4 a[76:79], v1, s[8:11], s60 offen offset:128 nt
    s_waitcnt vmcnt(6)
    buffer_load_dwordx4 a[80:83], v1, s[8:11], s60 offen offset:256 nt
    s_waitcnt vmcnt(6)
    buffer_load_dwordx4 a[84:87], v1, s[8:11], s60 offen offset:3072 nt
    s_waitcnt vmcnt(6)
    buffer_load_dwordx4 a[88:91], v1, s[8:11], s60 offen offset:3200 nt
    s_waitcnt vmcnt(6)
    buffer_load_dwordx4 a[92:95], v1, s[8:11], s60 offen offset:3328 nt
    s_waitcnt vmcnt(6)
    s_barrier
    s_cmp_lg_u32 s4, 2
    s_cbranch_scc1 Ls_5
    s_getreg_b32 s63, hwreg(HW_REG_XCC_ID)
    s_and_b32 s63, s63, 15
    s_mul_i32 s62, s63, s63
    s_lshl_b32 s62, s62, 18
    s_lshl_b32 s63, s63, 8
    s_add_u32 s62, s62, s63
    s_add_u32 s62, s62, 1
    s_lshl_b32 s60, s85, 5
    v_mov_b32 v16, s62
    s_mov_b64 exec, 1
    buffer_atomic_add v16, off, s[36:39], s60 sc1
    s_mov_b64 exec, -1
    s_nop 0
Ls_5:
    s_add_u32 s60, s57, 24576
    buffer_load_dwordx4 a[96:99], v1, s[8:11], s60 offen offset:0 nt
    s_waitcnt vmcnt(6)
    buffer_load_dwordx4 a[100:103], v1, s[8:11], s60 offen offset:128 nt
    s_waitcnt vmcnt(6)
    buffer_load_dwordx4 a[104:107], v1, s[8:11], s60 offen offset:256 nt
    s_waitcnt vmcnt(6)
    buffer_load_dwordx4 a[108:111], v1, s[8:11], s60 offen offset:3072 nt
    s_waitcnt vmcnt(6)
    buffer_load_dwordx4 a[112:115], v1, s[8:11], s60 offen offset:3200 nt
    s_waitcnt vmcnt(6)
    buffer_load_dwordx4 a[116:119], v1, s[8:11], s60 offen offset:3328 nt
    s_waitcnt vmcnt(6)
    s_add_u32 s60, s57, 30720
    buffer_load_dwordx4 a[120:123], v1, s[8:11], s60 offen offset:0 nt
    s_waitcnt vmcnt(6)
    buffer_load_dwordx4 a[124:127], v1, s[8:11], s60 offen offset:128 nt
    s_waitcnt vmcnt(6)
    buffer_load_dwordx4 a[128:131], v1, s[8:11], s60 offen offset:256 nt
    s_waitcnt vmcnt(6)
    buffer_load_dwordx4 a[132:135], v1, s[8:11], s60 offen offset:3072 nt
    s_waitcnt vmcnt(6)
    buffer_load_dwordx4 a[136:139], v1, s[8:11], s60 offen offset:3200 nt
    s_waitcnt vmcnt(6)
    buffer_load_dwordx4 a[140:143], v1, s[8:11], s60 offen offset:3328 nt
    s_waitcnt vmcnt(6)
    s_add_u32 s60, s57, 36864
    buffer_load_dwordx4 a[144:147], v1, s[8:11], s60 offen offset:0 nt
    s_waitcnt vmcnt(6)
    buffer_load_dwordx4 a[148:151], v1, s[8:11], s60 offen offset:128 nt
    s_waitcnt vmcnt(6)
    buffer_load_dwordx4 a[152:155], v1, s[8:11], s60 offen offset:256 nt
    s_waitcnt vmcnt(6)
    buffer_load_dwordx4 a[156:159], v1, s[8:11], s60 offen offset:3072 nt
    s_waitcnt vmcnt(6)
    buffer_load_dwordx4 a[160:163], v1, s[8:11], s60 offen offset:3200 nt
    s_waitcnt vmcnt(6)
    buffer_load_dwordx4 a[164:167], v1, s[8:11], s60 offen offset:3328 nt
    s_waitcnt vmcnt(6)
    s_add_u32 s60, s57, 43008
    buffer_load_dwordx4 a[168:171], v1, s[8:11], s60 offen offset:0 nt
    s_waitcnt vmcnt(6)
    buffer_load_dwordx4 a[172:175], v1, s[8:11], s60 offen offset:128 nt
    s_waitcnt vmcnt(6)
    buffer_load_dwordx4 a[176:179], v1, s[8:11], s60 offen offset:256 nt
    s_waitcnt vmcnt(6)
    buffer_load_dwordx4 a[180:183], v1, s[8:11], s60 offen offset:3072 nt
    s_waitcnt vmcnt(6)
    buffer_load_dwordx4 a[184:187], v1, s[8:11], s60 offen offset:3200 nt
    s_waitcnt vmcnt(6)
    buffer_load_dwordx4 a[188:191], v1, s[8:11], s60 offen offset:3328 nt
    s_waitcnt vmcnt(6)
    s_add_u32 s60, s57, 49152
    buffer_load_dwordx4 a[192:195], v1, s[8:11], s60 offen offset:0 nt
    s_waitcnt vmcnt(6)
    buffer_load_dwordx4 a[196:199], v1, s[8:11], s60 offen offset:128 nt
    s_waitcnt vmcnt(6)
    buffer_load_dwordx4 a[200:203], v1, s[8:11], s60 offen offset:256 nt
    s_waitcnt vmcnt(6)
    buffer_load_dwordx4 a[204:207], v1, s[8:11], s60 offen offset:3072 nt
    s_waitcnt vmcnt(6)
    buffer_load_dwordx4 a[208:211], v1, s[8:11], s60 offen offset:3200 nt
    s_waitcnt vmcnt(6)
    buffer_load_dwordx4 a[212:215], v1, s[8:11], s60 offen offset:3328 nt
    s_waitcnt vmcnt(6)
    s_add_u32 s60, s57, 55296
    buffer_load_dwordx4 a[216:219], v1, s[8:11], s60 offen offset:0 nt
    s_waitcnt vmcnt(6)
    buffer_load_dwordx4 a[220:223], v1, s[8:11], s60 offen offset:128 nt
    s_waitcnt vmcnt(6)
    buffer_load_dwordx4 a[224:227], v1, s[8:11], s60 offen offset:256 nt
    s_waitcnt vmcnt(6)
    buffer_load_dwordx4 a[228:231], v1, s[8:11], s60 offen offset:3072 nt
    s_waitcnt vmcnt(6)
    buffer_load_dwordx4 a[232:235], v1, s[8:11], s60 offen offset:3200 nt
    s_waitcnt vmcnt(6)
    buffer_load_dwordx4 a[236:239], v1, s[8:11], s60 offen offset:3328 nt
    s_waitcnt vmcnt(6)
    s_add_u32 s60, s57, 61440
    buffer_load_dwordx4 a[240:243], v1, s[8:11], s60 offen offset:0 nt
    s_waitcnt vmcnt(6)
    buffer_load_dwordx4 a[244:247], v1, s[8:11], s60 offen offset:128 nt
    s_waitcnt vmcnt(6)
    buffer_load_dwordx4 a[248:251], v1, s[8:11], s60 offen offset:256 nt
    s_waitcnt vmcnt(6)
    buffer_load_dwordx4 a[252:255], v1, s[8:11], s60 offen offset:3072 nt
    s_waitcnt vmcnt(6)
    buffer_load_dwordx4 v[128:131], v1, s[8:11], s60 offen offset:3200 nt
    s_waitcnt vmcnt(6)
    buffer_load_dwordx4 v[132:135], v1, s[8:11], s60 offen offset:3328 nt
    s_waitcnt vmcnt(6)
    v_lshlrev_b32 v16, 1, v0
    s_mov_b64 exec, 0xff
    buffer_load_dword v17, v16, s[36:39], 0 offen sc1
    s_mov_b64 exec, -1
    s_add_u32 s60, s57, 67584
    buffer_load_dwordx4 v[136:139], v1, s[8:11], s60 offen offset:0 nt
    s_waitcnt vmcnt(6)
    buffer_load_dwordx4 v[140:143], v1, s[8:11], s60 offen offset:128 nt
    s_waitcnt vmcnt(6)
    buffer_load_dwordx4 v[144:147], v1, s[8:11], s60 offen offset:256 nt
    s_waitcnt vmcnt(6)
    buffer_load_dwordx4 v[148:151], v1, s[8:11], s60 offen offset:3072 nt
    s_waitcnt vmcnt(6)
    buffer_load_dwordx4 v[152:155], v1, s[8:11], s60 offen offset:3200 nt
    s_waitcnt vmcnt(6)
    buffer_load_dwordx4 v[156:159], v1, s[8:11], s60 offen offset:3328 nt
    s_waitcnt vmcnt(6)
    s_mov_b64 exec, 0xff
    s_mov_b32 s59, 262144
Lcnt:
    v_and_b32 v18, 0xff, v17
    v_cmp_gt_u32 vcc, 32, v18
    s_sub_u32 s59, s59, 1
    s_cbranch_scc1 Lcntx
    s_cbranch_vccz Lcntx
    s_sleep 8
    buffer_load_dword v17, v16, s[36:39], 0 offen sc1
    s_waitcnt vmcnt(0)
    s_branch Lcnt
Lcntx:
    s_mov_b64 exec, -1
    v_readlane_b32 s95, v17, s85
    s_getreg_b32 s63, hwreg(HW_REG_XCC_ID)
    s_and_b32 s63, s63, 15
    s_mul_i32 s62, s63, s63
    s_lshl_b32 s62, s62, 23
    s_lshl_b32 s63, s63, 13
    s_add_u32 s62, s62, s63
    s_add_u32 s62, s62, 32
    s_cmp_eq_u32 s62, s95
    s_cselect_b32 s6, 1, 0
    s_mov_b32 s5, -1
    s_cmp_lg_u32 s4, 0
    s_cbranch_scc1 Li5
    s_call_b64 s[70:71], Lcissue
    s_add_u32 s60, s57, 73728
    buffer_load_dwordx4 v[160:163], v1, s[8:11], s60 offen offset:0 nt
    s_waitcnt vmcnt(16)
    buffer_load_dwordx4 v[164:167], v1, s[8:11], s60 offen offset:128 nt
    s_waitcnt vmcnt(16)
    buffer_load_dwordx4 v[168:171], v1, s[8:11], s60 offen offset:256 nt
    s_waitcnt vmcnt(16)
    buffer_load_dwordx4 v[172:175], v1, s[8:11], s60 offen offset:3072 nt
    s_waitcnt vmcnt(16)
    buffer_load_dwordx4 v[176:179], v1, s[8:11], s60 offen offset:3200 nt
    s_waitcnt vmcnt(16)
    buffer_load_dwordx4 v[180:183], v1, s[8:11], s60 offen offset:3328 nt
    s_waitcnt vmcnt(16)
    s_add_u32 s60, s57, 79872
    buffer_load_dwordx4 v[184:187], v1, s[8:11], s60 offen offset:0 nt
    buffer_load_dwordx4 v[188:191], v1, s[8:11], s60 offen offset:128 nt
    buffer_load_dwordx4 v[192:195], v1, s[8:11], s60 offen offset:256 nt
    s_waitcnt vmcnt(9)
    s_call_b64 s[72:73], Lccheck
    s_add_u32 s60, s57, 79872
    s_branch Li6
Li5:
    s_add_u32 s60, s57, 73728
    buffer_load_dwordx4 v[160:163], v1, s[8:11], s60 offen offset:0 nt
    s_waitcnt vmcnt(6)
    buffer_load_dwordx4 v[164:167], v1, s[8:11], s60 offen offset:128 nt
    s_waitcnt vmcnt(6)
    buffer_load_dwordx4 v[168:171], v1, s[8:11], s60 offen offset:256 nt
    s_waitcnt vmcnt(6)
    buffer_load_dwordx4 v[172:175], v1, s[8:11], s60 offen offset:3072 nt
    s_waitcnt vmcnt(6)
    buffer_load_dwordx4 v[176:179], v1, s[8:11], s60 offen offset:3200 nt
    s_waitcnt vmcnt(6)
    buffer_load_dwordx4 v[180:183], v1, s[8:11], s60 offen offset:3328 nt
    s_waitcnt vmcnt(6)
    s_add_u32 s60, s57, 79872
    buffer_load_dwordx4 v[184:187], v1, s[8:11], s60 offen offset:0 nt
    s_waitcnt vmcnt(6)
    buffer_load_dwordx4 v[188:191], v1, s[8:11], s60 offen offset:128 nt
    s_waitcnt vmcnt(6)
    buffer_load_dwordx4 v[192:195], v1, s[8:11], s60 offen offset:256 nt
    s_waitcnt vmcnt(6)
Li6:
    buffer_load_dwordx4 v[196:199], v1, s[8:11], s60 offen offset:3072 nt
    s_waitcnt vmcnt(6)
    buffer_load_dwordx4 v[200:203], v1, s[8:11], s60 offen offset:3200 nt
    s_waitcnt vmcnt(6)
    buffer_load_dwordx4 v[204:207], v1, s[8:11], s60 offen offset:3328 nt
    s_waitcnt vmcnt(6)
    s_add_u32 s60, s57, 86016
    buffer_load_dwordx4 v[208:211], v1, s[8:11], s60 offen offset:0 nt
    s_waitcnt vmcnt(6)
    buffer_load_dwordx4 v[212:215], v1, s[8:11], s60 offen offset:128 nt
    s_waitcnt vmcnt(6)
    buffer_load_dwordx4 v[216:219], v1, s[8:11], s60 offen offset:256 nt
    s_waitcnt vmcnt(6)
    buffer_load_dwordx4 v[220:223], v1, s[8:11], s60 offen offset:3072 nt
    s_waitcnt vmcnt(6)
    buffer_load_dwordx4 v[224:227], v1, s[8:11], s60 offen offset:3200 nt
    s_waitcnt vmcnt(6)
    buffer_load_dwordx4 v[228:231], v1, s[8:11], s60 offen offset:3328 nt
    s_waitcnt vmcnt(6)
    s_add_u32 s60, s57, 92160
    buffer_load_dwordx4 v[232:235], v1, s[8:11], s60 offen offset:0 nt
    s_waitcnt vmcnt(6)
    buffer_load_dwordx4 v[236:239], v1, s[8:11], s60 offen offset:128 nt
    s_waitcnt vmcnt(6)
    buffer_load_dwordx4 v[240:243], v1, s[8:11], s60 offen offset:256 nt
    s_waitcnt vmcnt(6)
    buffer_load_dwordx4 v[244:247], v1, s[8:11], s60 offen offset:3072 nt
    s_waitcnt vmcnt(6)
    buffer_load_dwordx4 v[248:251], v1, s[8:11], s60 offen offset:3200 nt
    s_waitcnt vmcnt(6)
    buffer_load_dwordx4 v[252:255], v1, s[8:11], s60 offen offset:3328 nt
    s_waitcnt vmcnt(6)
    s_add_u32 m0, s80, 106496
    s_add_u32 s60, s57, 24960
    buffer_load_dwordx4 v2, s[12:15], s60 offen nt lds
    s_waitcnt vmcnt(6)
    s_add_u32 m0, s80, 110592
    s_add_u32 s60, s57, 25088
    buffer_load_dwordx4 v2, s[12:15], s60 offen nt lds
    s_waitcnt vmcnt(6)
    s_add_u32 m0, s80, 114688
    s_add_u32 s60, s57, 25216
    buffer_load_dwordx4 v2, s[12:15], s60 offen nt lds
    s_waitcnt vmcnt(6)
    s_add_u32 m0, s80, 118784
    s_add_u32 s60, s57, 25344
    buffer_load_dwordx4 v2, s[12:15], s60 offen nt lds
    s_waitcnt vmcnt(6)
    s_add_u32 m0, s80, 122880
    s_add_u32 s60, s57, 25472
    buffer_load_dwordx4 v2, s[12:15], s60 offen nt lds
    s_waitcnt vmcnt(6)
    s_add_u32 m0, s80, 126976
    s_add_u32 s60, s57, 25600
    buffer_load_dwordx4 v2, s[12:15], s60 offen nt lds
    s_waitcnt vmcnt(6)
    s_add_u32 m0, s80, 131072
    s_add_u32 s60, s57, 25728
    buffer_load_dwordx4 v2, s[12:15], s60 offen nt lds
    s_waitcnt vmcnt(6)
    s_add_u32 m0, s80, 135168
    s_add_u32 s60, s57, 25856
    buffer_load_dwordx4 v2, s[12:15], s60 offen nt lds
    s_waitcnt vmcnt(6)
    s_add_u32 m0, s80, 139264
    s_add_u32 s60, s57, 25984
    buffer_load_dwordx4 v2, s[12:15], s60 offen nt lds
    s_waitcnt vmcnt(6)
    s_add_u32 m0, s80, 143360
    s_add_u32 s60, s57, 26112
    buffer_load_dwordx4 v2, s[12:15], s60 offen nt lds
    s_waitcnt vmcnt(6)
    s_add_u32 m0, s80, 147456
    s_add_u32 s60, s57, 26240
    buffer_load_dwordx4 v2, s[12:15], s60 offen nt lds
    s_waitcnt vmcnt(6)
    s_add_u32 m0, s80, 151552
    s_add_u32 s60, s57, 26368
    buffer_load_dwordx4 v2, s[12:15], s60 offen nt lds
    s_waitcnt vmcnt(6)
    s_add_u32 s63, s57, 0
    buffer_load_dwordx4 v[68:71], v2, s[12:15], s63 offen offset:0 sc1
    s_waitcnt vmcnt(6)
    buffer_load_dwordx4 v[72:75], v2, s[12:15], s63 offen offset:128 sc1
    s_waitcnt vmcnt(6)
    buffer_load_dwordx4 v[76:79], v2, s[12:15], s63 offen offset:256 sc1
    s_waitcnt vmcnt(6)
    s_add_u32 s63, s57, 0
    buffer_load_dwordx4 v[80:83], v2, s[12:15], s63 offen offset:384 sc1
    s_waitcnt vmcnt(6)
    buffer_load_dwordx4 v[84:87], v2, s[12:15], s63 offen offset:512 sc1
    s_waitcnt vmcnt(6)
    buffer_load_dwordx4 v[88:91], v2, s[12:15], s63 offen offset:640 sc1
    s_waitcnt vmcnt(6)
    s_add_u32 s63, s57, 0
    buffer_load_dwordx4 v[92:95], v2, s[12:15], s63 offen offset:768 sc1
    s_waitcnt vmcnt(15)
    buffer_load_dwordx4 v[96:99], v2, s[12:15], s63 offen offset:896 sc1
    s_waitcnt vmcnt(15)
    buffer_load_dwordx4 v[100:103], v2, s[12:15], s63 offen offset:1024 sc1
    s_waitcnt vmcnt(15)
    s_add_u32 s63, s57, 0
    buffer_load_dwordx4 v[104:107], v2, s[12:15], s63 offen offset:1152 sc1
    s_waitcnt vmcnt(15)
    buffer_load_dwordx4 v[108:111], v2, s[12:15], s63 offen offset:1280 sc1
    s_waitcnt vmcnt(15)
    buffer_load_dwordx4 v[112:115], v2, s[12:15], s63 offen offset:1408 sc1
    s_waitcnt vmcnt(15)
    s_add_u32 s63, s57, 0
    buffer_load_dwordx4 v[116:119], v2, s[12:15], s63 offen offset:1536 sc1
    s_waitcnt vmcnt(15)
    buffer_load_dwordx4 v[120:123], v2, s[12:15], s63 offen offset:1664 sc1
    s_waitcnt vmcnt(15)
    buffer_load_dwordx4 v[124:127], v2, s[12:15], s63 offen offset:1792 sc1
    s_waitcnt vmcnt(15)
    v_lshrrev_b32 v16, 7, v0
    v_mul_u32_u24 v1, 384, v16
    v_and_b32 v16, 0x70, v0
    v_bfe_u32 v17, v0, 8, 1
    v_lshlrev_b32 v17, 6, v17
    v_xor_b32 v16, v16, v17
    v_add_u32 v1, v1, v16
    s_barrier
    s_mov_b32 s5, 0
    s_mov_b32 s82, 162944
    s_call_b64 s[70:71], Lqka
    v_add_u32 v10, 0x10000, v3
    v_add_u32 v11, 0x20000, v3
    v_mov_b32_dpp v36, v44 row_newbcast:0 row_mask:0xf bank_mask:0xf
    v_perm_b32 v12, v36, v36, v4
    v_perm_b32 v13, v36, v36, v5
    v_perm_b32 v14, v36, v36, v6
    v_perm_b32 v15, v36, v36, v7
    s_waitcnt vmcnt(14)
    s_nop 0
    v_mfma_f32_16x16x32_bf16 v[24:27], v[12:15], v[68:71], 0
    v_mov_b32_dpp v36, v44 row_newbcast:1 row_mask:0xf bank_mask:0xf
    v_perm_b32 v16, v36, v36, v4
    s_waitcnt vmcnt(13)
    v_mfma_f32_16x16x32_bf16 v[28:31], v[12:15], v[72:75], 0
    v_perm_b32 v17, v36, v36, v5
    v_perm_b32 v18, v36, v36, v6
    v_perm_b32 v19, v36, v36, v7
    s_waitcnt vmcnt(12)
    v_mfma_f32_16x16x32_bf16 v[32:35], v[12:15], v[76:79], 0
    s_waitcnt vmcnt(11)
    v_mfma_f32_16x16x32_bf16 v[24:27], v[16:19], v[80:83], v[24:27]
    v_mov_b32_dpp v36, v44 row_newbcast:2 row_mask:0xf bank_mask:0xf
    v_perm_b32 v12, v36, v36, v4
    s_waitcnt vmcnt(10)
    v_mfma_f32_16x16x32_bf16 v[28:31], v[16:19], v[84:87], v[28:31]
    v_perm_b32 v13, v36, v36, v5
    v_perm_b32 v14, v36, v36, v6
    v_perm_b32 v15, v36, v36, v7
    s_waitcnt vmcnt(9)
    v_mfma_f32_16x16x32_bf16 v[32:35], v[16:19], v[88:91], v[32:35]
    s_waitcnt vmcnt(8)
    v_mfma_f32_16x16x32_bf16 v[24:27], v[12:15], v[92:95], v[24:27]
    v_mov_b32_dpp v36, v44 row_newbcast:3 row_mask:0xf bank_mask:0xf
    v_perm_b32 v16, v36, v36, v4
    s_waitcnt vmcnt(7)
    v_mfma_f32_16x16x32_bf16 v[28:31], v[12:15], v[96:99], v[28:31]
    v_perm_b32 v17, v36, v36, v5
    v_perm_b32 v18, v36, v36, v6
    v_perm_b32 v19, v36, v36, v7
    s_waitcnt vmcnt(6)
    v_mfma_f32_16x16x32_bf16 v[32:35], v[12:15], v[100:103], v[32:35]
    s_add_u32 s63, s57, 0
    buffer_load_dwordx4 v[68:71], v2, s[12:15], s63 offen offset:1920 sc1
    s_waitcnt vmcnt(6)
    v_mfma_f32_16x16x32_bf16 v[24:27], v[16:19], v[104:107], v[24:27]
    v_mov_b32_dpp v36, v44 row_newbcast:4 row_mask:0xf bank_mask:0xf
    v_perm_b32 v12, v36, v36, v4
    buffer_load_dwordx4 v[72:75], v2, s[12:15], s63 offen offset:2048 sc1
    s_waitcnt vmcnt(6)
    v_mfma_f32_16x16x32_bf16 v[28:31], v[16:19], v[108:111], v[28:31]
    v_perm_b32 v13, v36, v36, v5
    v_perm_b32 v14, v36, v36, v6
    v_perm_b32 v15, v36, v36, v7
    buffer_load_dwordx4 v[76:79], v2, s[12:15], s63 offen offset:2176 sc1
    s_waitcnt vmcnt(6)
    v_mfma_f32_16x16x32_bf16 v[32:35], v[16:19], v[112:115], v[32:35]
    buffer_load_dwordx4 v[80:83], v2, s[12:15], s63 offen offset:2304 sc1
    s_waitcnt vmcnt(6)
    v_mfma_f32_16x16x32_bf16 v[24:27], v[12:15], v[116:119], v[24:27]
    v_mov_b32_dpp v36, v44 row_newbcast:5 row_mask:0xf bank_mask:0xf
    v_perm_b32 v16, v36, v36, v4
    buffer_load_dwordx4 v[84:87], v2, s[12:15], s63 offen offset:2432 sc1
    s_waitcnt vmcnt(6)
    v_mfma_f32_16x16x32_bf16 v[28:31], v[12:15], v[120:123], v[28:31]
    v_perm_b32 v17, v36, v36, v5
    v_perm_b32 v18, v36, v36, v6
    v_perm_b32 v19, v36, v36, v7
    buffer_load_dwordx4 v[88:91], v2, s[12:15], s63 offen offset:2560 sc1
    s_waitcnt vmcnt(6)
    v_mfma_f32_16x16x32_bf16 v[32:35], v[12:15], v[124:127], v[32:35]
    buffer_load_dwordx4 v[92:95], v2, s[12:15], s63 offen offset:2688 sc1
    s_waitcnt vmcnt(6)
    v_mfma_f32_16x16x32_bf16 v[24:27], v[16:19], v[68:71], v[24:27]
    v_mov_b32_dpp v36, v44 row_newbcast:6 row_mask:0xf bank_mask:0xf
    v_perm_b32 v12, v36, v36, v4
    buffer_load_dwordx4 v[96:99], v2, s[12:15], s63 offen offset:2816 sc1
    s_waitcnt vmcnt(6)
    v_mfma_f32_16x16x32_bf16 v[28:31], v[16:19], v[72:75], v[28:31]
    v_perm_b32 v13, v36, v36, v5
    v_perm_b32 v14, v36, v36, v6
    v_perm_b32 v15, v36, v36, v7
    buffer_load_dwordx4 v[100:103], v2, s[12:15], s63 offen offset:2944 sc1
    s_waitcnt vmcnt(6)
    v_mfma_f32_16x16x32_bf16 v[32:35], v[16:19], v[76:79], v[32:35]
    s_add_u32 s63, s57, 24576
    buffer_load_dwordx4 v[104:107], v2, s[12:15], s63 offen offset:0 sc1
    s_waitcnt vmcnt(6)
    v_mfma_f32_16x16x32_bf16 v[24:27], v[12:15], v[80:83], v[24:27]
    v_mov_b32_dpp v36, v44 row_newbcast:7 row_mask:0xf bank_mask:0xf
    v_perm_b32 v16, v36, v36, v4
    buffer_load_dwordx4 v[108:111], v2, s[12:15], s63 offen offset:128 sc1
    s_waitcnt vmcnt(6)
    v_mfma_f32_16x16x32_bf16 v[28:31], v[12:15], v[84:87], v[28:31]
    v_perm_b32 v17, v36, v36, v5
    v_perm_b32 v18, v36, v36, v6
    v_perm_b32 v19, v36, v36, v7
    buffer_load_dwordx4 v[112:115], v2, s[12:15], s63 offen offset:256 sc1
    s_waitcnt vmcnt(6)
    v_mfma_f32_16x16x32_bf16 v[32:35], v[12:15], v[88:91], v[32:35]
    buffer_load_dwordx4 v[116:119], v2, s[12:15], s63 offen offset:1920 sc1
    s_waitcnt vmcnt(6)
    v_mfma_f32_16x16x32_bf16 v[24:27], v[16:19], v[92:95], v[24:27]
    v_mov_b32_dpp v36, v45 row_newbcast:1 row_mask:0xf bank_mask:0xf
    v_perm_b32 v12, v36, v36, v4
    buffer_load_dwordx4 v[120:123], v2, s[12:15], s63 offen offset:2048 sc1
    s_waitcnt vmcnt(6)
    v_mfma_f32_16x16x32_bf16 v[28:31], v[16:19], v[96:99], v[28:31]
    v_perm_b32 v13, v36, v36, v5
    v_perm_b32 v14, v36, v36, v6
    v_perm_b32 v15, v36, v36, v7
    buffer_load_dwordx4 v[124:127], v2, s[12:15], s63 offen offset:2176 sc1
    s_waitcnt vmcnt(6)
    v_mfma_f32_16x16x32_bf16 v[32:35], v[16:19], v[100:103], v[32:35]
    ds_read_b128 v[48:51], v10 offset:40960
    ds_read_b128 v[52:55], v10 offset:45056
    ds_read_b128 v[56:59], v10 offset:49152
    s_waitcnt lgkmcnt(2)
    v_mfma_f32_16x16x32_bf16 v[24:27], v[12:15], v[48:51], v[24:27]
    v_mov_b32_dpp v36, v45 row_newbcast:0 row_mask:0xf bank_mask:0xf
    v_perm_b32 v16, v36, v36, v4
    s_waitcnt lgkmcnt(1)
    v_mfma_f32_16x16x32_bf16 v[28:31], v[12:15], v[52:55], v[28:31]
    v_perm_b32 v17, v36, v36, v5
    v_perm_b32 v18, v36, v36, v6
    v_perm_b32 v19, v36, v36, v7
    s_waitcnt lgkmcnt(0)
    v_mfma_f32_16x16x32_bf16 v[32:35], v[12:15], v[56:59], v[32:35]
    buffer_load_dwordx4 v[68:71], v2, s[12:15], s63 offen offset:2304 sc1
    s_waitcnt vmcnt(6)
    v_mfma_f32_16x16x32_bf16 v[24:27], v[16:19], v[104:107], v[24:27]
    v_mov_b32_dpp v36, v45 row_newbcast:2 row_mask:0xf bank_mask:0xf
    v_perm_b32 v12, v36, v36, v4
    buffer_load_dwordx4 v[72:75], v2, s[12:15], s63 offen offset:2432 sc1
    s_waitcnt vmcnt(6)
    v_mfma_f32_16x16x32_bf16 v[28:31], v[16:19], v[108:111], v[28:31]
    v_perm_b32 v13, v36, v36, v5
    v_perm_b32 v14, v36, v36, v6
    v_perm_b32 v15, v36, v36, v7
    buffer_load_dwordx4 v[76:79], v2, s[12:15], s63 offen offset:2560 sc1
    s_waitcnt vmcnt(6)
    v_mfma_f32_16x16x32_bf16 v[32:35], v[16:19], v[112:115], v[32:35]
    ds_read_b128 v[48:51], v10 offset:53248
    ds_read_b128 v[52:55], v10 offset:57344
    ds_read_b128 v[56:59], v10 offset:61440
    s_waitcnt lgkmcnt(2)
    v_mfma_f32_16x16x32_bf16 v[24:27], v[12:15], v[48:51], v[24:27]
    v_mov_b32_dpp v36, v45 row_newbcast:5 row_mask:0xf bank_mask:0xf
    v_perm_b32 v16, v36, v36, v4
    s_waitcnt lgkmcnt(1)
    v_mfma_f32_16x16x32_bf16 v[28:31], v[12:15], v[52:55], v[28:31]
    v_perm_b32 v17, v36, v36, v5
    v_perm_b32 v18, v36, v36, v6
    v_perm_b32 v19, v36, v36, v7
    s_waitcnt lgkmcnt(0)
    v_mfma_f32_16x16x32_bf16 v[32:35], v[12:15], v[56:59], v[32:35]
    buffer_load_dwordx4 v[80:83], v2, s[12:15], s63 offen offset:2688 sc1
    s_waitcnt vmcnt(6)
    v_mfma_f32_16x16x32_bf16 v[24:27], v[16:19], v[116:119], v[24:27]
    v_mov_b32_dpp v36, v45 row_newbcast:3 row_mask:0xf bank_mask:0xf
    v_perm_b32 v12, v36, v36, v4
    buffer_load_dwordx4 v[84:87], v2, s[12:15], s63 offen offset:2816 sc1
    s_waitcnt vmcnt(6)
    v_mfma_f32_16x16x32_bf16 v[28:31], v[16:19], v[120:123], v[28:31]
    v_perm_b32 v13, v36, v36, v5
    v_perm_b32 v14, v36, v36, v6
    v_perm_b32 v15, v36, v36, v7
    buffer_load_dwordx4 v[88:91], v2, s[12:15], s63 offen offset:2944 sc1
    s_waitcnt vmcnt(6)
    v_mfma_f32_16x16x32_bf16 v[32:35], v[16:19], v[124:127], v[32:35]
    ds_read_b128 v[48:51], v11 offset:0
    ds_read_b128 v[52:55], v11 offset:4096
    ds_read_b128 v[56:59], v11 offset:8192
    s_waitcnt lgkmcnt(2)
    v_mfma_f32_16x16x32_bf16 v[24:27], v[12:15], v[48:51], v[24:27]
    v_mov_b32_dpp v36, v45 row_newbcast:6 row_mask:0xf bank_mask:0xf
    v_perm_b32 v16, v36, v36, v4
    s_waitcnt lgkmcnt(1)
    v_mfma_f32_16x16x32_bf16 v[28:31], v[12:15], v[52:55], v[28:31]
    v_perm_b32 v17, v36, v36, v5
    v_perm_b32 v18, v36, v36, v6
    v_perm_b32 v19, v36, v36, v7
    s_waitcnt lgkmcnt(0)
    v_mfma_f32_16x16x32_bf16 v[32:35], v[12:15], v[56:59], v[32:35]
    s_add_u32 s63, s57, 49152
    buffer_load_dwordx4 v[92:95], v2, s[12:15], s63 offen offset:0 sc1
    s_waitcnt vmcnt(6)
    v_mfma_f32_16x16x32_bf16 v[24:27], v[16:19], v[68:71], v[24:27]
    v_mov_b32_dpp v36, v45 row_newbcast:4 row_mask:0xf bank_mask:0xf
    v_perm_b32 v12, v36, v36, v4
    buffer_load_dwordx4 v[96:99], v2, s[12:15], s63 offen offset:128 sc1
    s_waitcnt vmcnt(6)
    v_mfma_f32_16x16x32_bf16 v[28:31], v[16:19], v[72:75], v[28:31]
    v_perm_b32 v13, v36, v36, v5
    v_perm_b32 v14, v36, v36, v6
    v_perm_b32 v15, v36, v36, v7
    buffer_load_dwordx4 v[100:103], v2, s[12:15], s63 offen offset:256 sc1
    s_waitcnt vmcnt(6)
    v_mfma_f32_16x16x32_bf16 v[32:35], v[16:19], v[76:79], v[32:35]
    ds_read_b128 v[48:51], v11 offset:12288
    ds_read_b128 v[52:55], v11 offset:16384
    ds_read_b128 v[56:59], v11 offset:20480
    s_waitcnt lgkmcnt(2)
    v_mfma_f32_16x16x32_bf16 v[24:27], v[12:15], v[48:51], v[24:27]
    v_mov_b32_dpp v36, v45 row_newbcast:7 row_mask:0xf bank_mask:0xf
    v_perm_b32 v16, v36, v36, v4
    s_waitcnt lgkmcnt(1)
    v_mfma_f32_16x16x32_bf16 v[28:31], v[12:15], v[52:55], v[28:31]
    v_perm_b32 v17, v36, v36, v5
    v_perm_b32 v18, v36, v36, v6
    v_perm_b32 v19, v36, v36, v7
    s_waitcnt lgkmcnt(0)
    v_mfma_f32_16x16x32_bf16 v[32:35], v[12:15], v[56:59], v[32:35]
    buffer_load_dwordx4 v[104:107], v2, s[12:15], s63 offen offset:384 sc1
    s_waitcnt vmcnt(6)
    v_mfma_f32_16x16x32_bf16 v[24:27], v[16:19], v[80:83], v[24:27]
    v_mov_b32_dpp v36, v46 row_newbcast:0 row_mask:0xf bank_mask:0xf
    v_perm_b32 v12, v36, v36, v4
    buffer_load_dwordx4 v[108:111], v2, s[12:15], s63 offen offset:512 sc1
    s_waitcnt vmcnt(6)
    v_mfma_f32_16x16x32_bf16 v[28:31], v[16:19], v[84:87], v[28:31]
    v_perm_b32 v13, v36, v36, v5
    v_perm_b32 v14, v36, v36, v6
    v_perm_b32 v15, v36, v36, v7
    buffer_load_dwordx4 v[112:115], v2, s[12:15], s63 offen offset:640 sc1
    s_waitcnt vmcnt(6)
    v_mfma_f32_16x16x32_bf16 v[32:35], v[16:19], v[88:91], v[32:35]
    buffer_load_dwordx4 v[116:119], v2, s[12:15], s63 offen offset:768 sc1
    s_waitcnt vmcnt(6)
    v_mfma_f32_16x16x32_bf16 v[24:27], v[12:15], v[92:95], v[24:27]
    v_mov_b32_dpp v36, v46 row_newbcast:1 row_mask:0xf bank_mask:0xf
    v_perm_b32 v16, v36, v36, v4
    buffer_load_dwordx4 v[120:123], v2, s[12:15], s63 offen offset:896 sc1
    s_waitcnt vmcnt(6)
    v_mfma_f32_16x16x32_bf16 v[28:31], v[12:15], v[96:99], v[28:31]
    v_perm_b32 v17, v36, v36, v5
    v_perm_b32 v18, v36, v36, v6
    v_perm_b32 v19, v36, v36, v7
    buffer_load_dwordx4 v[124:127], v2, s[12:15], s63 offen offset:1024 sc1
    s_waitcnt vmcnt(6)
    v_mfma_f32_16x16x32_bf16 v[32:35], v[12:15], v[100:103], v[32:35]
    buffer_load_dwordx4 v[68:71], v2, s[12:15], s63 offen offset:1152 sc1
    s_waitcnt vmcnt(6)
    v_mfma_f32_16x16x32_bf16 v[24:27], v[16:19], v[104:107], v[24:27]
    v_mov_b32_dpp v36, v46 row_newbcast:2 row_mask:0xf bank_mask:0xf
    v_perm_b32 v12, v36, v36, v4
    buffer_load_dwordx4 v[72:75], v2, s[12:15], s63 offen offset:1280 sc1
    s_waitcnt vmcnt(6)
    v_mfma_f32_16x16x32_bf16 v[28:31], v[16:19], v[108:111], v[28:31]
    v_perm_b32 v13, v36, v36, v5
    v_perm_b32 v14, v36, v36, v6
    v_perm_b32 v15, v36, v36, v7
    buffer_load_dwordx4 v[76:79], v2, s[12:15], s63 offen offset:1408 sc1
    s_waitcnt vmcnt(6)
    v_mfma_f32_16x16x32_bf16 v[32:35], v[16:19], v[112:115], v[32:35]
    buffer_load_dwordx4 v[80:83], v2, s[12:15], s63 offen offset:1536 sc1
    s_waitcnt vmcnt(6)
    v_mfma_f32_16x16x32_bf16 v[24:27], v[12:15], v[116:119], v[24:27]
    v_mov_b32_dpp v36, v46 row_newbcast:3 row_mask:0xf bank_mask:0xf
    v_perm_b32 v16, v36, v36, v4
    buffer_load_dwordx4 v[84:87], v2, s[12:15], s63 offen offset:1664 sc1
    s_waitcnt vmcnt(6)
    v_mfma_f32_16x16x32_bf16 v[28:31], v[12:15], v[120:123], v[28:31]
    v_perm_b32 v17, v36, v36, v5
    v_perm_b32 v18, v36, v36, v6
    v_perm_b32 v19, v36, v36, v7
    buffer_load_dwordx4 v[88:91], v2, s[12:15], s63 offen offset:1792 sc1
    s_waitcnt vmcnt(6)
    v_mfma_f32_16x16x32_bf16 v[32:35], v[12:15], v[124:127], v[32:35]
    buffer_load_dwordx4 v[92:95], v2, s[12:15], s63 offen offset:1920 sc1
    s_waitcnt vmcnt(6)
    v_mfma_f32_16x16x32_bf16 v[24:27], v[16:19], v[68:71], v[24:27]
    v_mov_b32_dpp v36, v46 row_newbcast:4 row_mask:0xf bank_mask:0xf
    v_perm_b32 v12, v36, v36, v4
    buffer_load_dwordx4 v[96:99], v2, s[12:15], s63 offen offset:2048 sc1
    s_waitcnt vmcnt(6)
    v_mfma_f32_16x16x32_bf16 v[28:31], v[16:19], v[72:75], v[28:31]
    v_perm_b32 v13, v36, v36, v5
    v_perm_b32 v14, v36, v36, v6
    v_perm_b32 v15, v36, v36, v7
    buffer_load_dwordx4 v[100:103], v2, s[12:15], s63 offen offset:2176 sc1
    s_waitcnt vmcnt(6)
    v_mfma_f32_16x16x32_bf16 v[32:35], v[16:19], v[76:79], v[32:35]
    buffer_load_dwordx4 v[104:107], v2, s[12:15], s63 offen offset:2304 sc1
    s_waitcnt vmcnt(6)
    v_mfma_f32_16x16x32_bf16 v[24:27], v[12:15], v[80:83], v[24:27]
    v_mov_b32_dpp v36, v46 row_newbcast:5 row_mask:0xf bank_mask:0xf
    v_perm_b32 v16, v36, v36, v4
    buffer_load_dwordx4 v[108:111], v2, s[12:15], s63 offen offset:2432 sc1
    s_waitcnt vmcnt(6)
    v_mfma_f32_16x16x32_bf16 v[28:31], v[12:15], v[84:87], v[28:31]
    v_perm_b32 v17, v36, v36, v5
    v_perm_b32 v18, v36, v36, v6
    v_perm_b32 v19, v36, v36, v7
    buffer_load_dwordx4 v[112:115], v2, s[12:15], s63 offen offset:2560 sc1
    s_waitcnt vmcnt(6)
    v_mfma_f32_16x16x32_bf16 v[32:35], v[12:15], v[88:91], v[32:35]
    buffer_load_dwordx4 v[116:119], v2, s[12:15], s63 offen offset:2688 sc1
    s_waitcnt vmcnt(6)
    v_mfma_f32_16x16x32_bf16 v[24:27], v[16:19], v[92:95], v[24:27]
    v_mov_b32_dpp v36, v46 row_newbcast:6 row_mask:0xf bank_mask:0xf
    v_perm_b32 v12, v36, v36, v4
    buffer_load_dwordx4 v[120:123], v2, s[12:15], s63 offen offset:2816 sc1
    s_waitcnt vmcnt(6)
    v_mfma_f32_16x16x32_bf16 v[28:31], v[16:19], v[96:99], v[28:31]
    v_perm_b32 v13, v36, v36, v5
    v_perm_b32 v14, v36, v36, v6
    v_perm_b32 v15, v36, v36, v7
    buffer_load_dwordx4 v[124:127], v2, s[12:15], s63 offen offset:2944 sc1
    s_waitcnt vmcnt(6)
    v_mfma_f32_16x16x32_bf16 v[32:35], v[16:19], v[100:103], v[32:35]
    s_add_u32 s63, s57, 73728
    buffer_load_dwordx4 v[68:71], v2, s[12:15], s63 offen offset:0 sc1
    s_waitcnt vmcnt(6)
    v_mfma_f32_16x16x32_bf16 v[24:27], v[12:15], v[104:107], v[24:27]
    v_mov_b32_dpp v36, v46 row_newbcast:7 row_mask:0xf bank_mask:0xf
    v_perm_b32 v16, v36, v36, v4
    buffer_load_dwordx4 v[72:75], v2, s[12:15], s63 offen offset:128 sc1
    s_waitcnt vmcnt(6)
    v_mfma_f32_16x16x32_bf16 v[28:31], v[12:15], v[108:111], v[28:31]
    v_perm_b32 v17, v36, v36, v5
    v_perm_b32 v18, v36, v36, v6
    v_perm_b32 v19, v36, v36, v7
    buffer_load_dwordx4 v[76:79], v2, s[12:15], s63 offen offset:256 sc1
    s_waitcnt vmcnt(6)
    v_mfma_f32_16x16x32_bf16 v[32:35], v[12:15], v[112:115], v[32:35]
    buffer_load_dwordx4 v[80:83], v2, s[12:15], s63 offen offset:384 sc1
    s_waitcnt vmcnt(6)
    v_mfma_f32_16x16x32_bf16 v[24:27], v[16:19], v[116:119], v[24:27]
    v_mov_b32_dpp v36, v47 row_newbcast:0 row_mask:0xf bank_mask:0xf
    v_perm_b32 v12, v36, v36, v4
    buffer_load_dwordx4 v[84:87], v2, s[12:15], s63 offen offset:512 sc1
    s_waitcnt vmcnt(6)
    v_mfma_f32_16x16x32_bf16 v[28:31], v[16:19], v[120:123], v[28:31]
    v_perm_b32 v13, v36, v36, v5
    v_perm_b32 v14, v36, v36, v6
    v_perm_b32 v15, v36, v36, v7
    buffer_load_dwordx4 v[88:91], v2, s[12:15], s63 offen offset:640 sc1
    s_waitcnt vmcnt(6)
    v_mfma_f32_16x16x32_bf16 v[32:35], v[16:19], v[124:127], v[32:35]
    buffer_load_dwordx4 v[92:95], v2, s[12:15], s63 offen offset:768 sc1
    s_waitcnt vmcnt(6)
    v_mfma_f32_16x16x32_bf16 v[24:27], v[12:15], v[68:71], v[24:27]
    v_mov_b32_dpp v36, v47 row_newbcast:1 row_mask:0xf bank_mask:0xf
    v_perm_b32 v16, v36, v36, v4
    buffer_load_dwordx4 v[96:99], v2, s[12:15], s63 offen offset:896 sc1
    s_waitcnt vmcnt(6)
    v_mfma_f32_16x16x32_bf16 v[28:31], v[12:15], v[72:75], v[28:31]
    v_perm_b32 v17, v36, v36, v5
    v_perm_b32 v18, v36, v36, v6
    v_perm_b32 v19, v36, v36, v7
    buffer_load_dwordx4 v[100:103], v2, s[12:15], s63 offen offset:1024 sc1
    s_waitcnt vmcnt(6)
    v_mfma_f32_16x16x32_bf16 v[32:35], v[12:15], v[76:79], v[32:35]
    buffer_load_dwordx4 v[104:107], v2, s[12:15], s63 offen offset:1152 nt
    s_waitcnt vmcnt(6)
    v_mfma_f32_16x16x32_bf16 v[24:27], v[16:19], v[80:83], v[24:27]
    v_mov_b32_dpp v36, v47 row_newbcast:2 row_mask:0xf bank_mask:0xf
    v_perm_b32 v12, v36, v36, v4
    buffer_load_dwordx4 v[108:111], v2, s[12:15], s63 offen offset:1280 nt
    s_waitcnt vmcnt(6)
    v_mfma_f32_16x16x32_bf16 v[28:31], v[16:19], v[84:87], v[28:31]
    v_perm_b32 v13, v36, v36, v5
    v_perm_b32 v14, v36, v36, v6
    v_perm_b32 v15, v36, v36, v7
    buffer_load_dwordx4 v[112:115], v2, s[12:15], s63 offen offset:1408 nt
    s_waitcnt vmcnt(6)
    v_mfma_f32_16x16x32_bf16 v[32:35], v[16:19], v[88:91], v[32:35]
    buffer_load_dwordx4 v[116:119], v2, s[12:15], s63 offen offset:1536 nt
    s_waitcnt vmcnt(6)
    v_mfma_f32_16x16x32_bf16 v[24:27], v[12:15], v[92:95], v[24:27]
    v_mov_b32_dpp v36, v47 row_newbcast:3 row_mask:0xf bank_mask:0xf
    v_perm_b32 v16, v36, v36, v4
    buffer_load_dwordx4 v[120:123], v2, s[12:15], s63 offen offset:1664 nt
    s_waitcnt vmcnt(6)
    v_mfma_f32_16x16x32_bf16 v[28:31], v[12:15], v[96:99], v[28:31]
    v_perm_b32 v17, v36, v36, v5
    v_perm_b32 v18, v36, v36, v6
    v_perm_b32 v19, v36, v36, v7
    buffer_load_dwordx4 v[124:127], v2, s[12:15], s63 offen offset:1792 nt
    s_waitcnt vmcnt(6)
    v_mfma_f32_16x16x32_bf16 v[32:35], v[12:15], v[100:103], v[32:35]
    buffer_load_dwordx4 v[68:71], v2, s[12:15], s63 offen offset:1920 nt
    s_waitcnt vmcnt(6)
    v_mfma_f32_16x16x32_bf16 v[24:27], v[16:19], v[104:107], v[24:27]
    v_mov_b32_dpp v36, v47 row_newbcast:4 row_mask:0xf bank_mask:0xf
    v_perm_b32 v12, v36, v36, v4
    buffer_load_dwordx4 v[72:75], v2, s[12:15], s63 offen offset:2048 nt
    s_waitcnt vmcnt(6)
    v_mfma_f32_16x16x32_bf16 v[28:31], v[16:19], v[108:111], v[28:31]
    v_perm_b32 v13, v36, v36, v5
    v_perm_b32 v14, v36, v36, v6
    v_perm_b32 v15, v36, v36, v7
    buffer_load_dwordx4 v[76:79], v2, s[12:15], s63 offen offset:2176 nt
    s_waitcnt vmcnt(6)
    v_mfma_f32_16x16x32_bf16 v[32:35], v[16:19], v[112:115], v[32:35]
    buffer_load_dwordx4 v[80:83], v2, s[12:15], s63 offen offset:2304 nt
    s_waitcnt vmcnt(6)
    v_mfma_f32_16x16x32_bf16 v[24:27], v[12:15], v[116:119], v[24:27]
    v_mov_b32_dpp v36, v47 row_newbcast:5 row_mask:0xf bank_mask:0xf
    v_perm_b32 v16, v36, v36, v4
    buffer_load_dwordx4 v[84:87], v2, s[12:15], s63 offen offset:2432 nt
    s_waitcnt vmcnt(6)
    v_mfma_f32_16x16x32_bf16 v[28:31], v[12:15], v[120:123], v[28:31]
    v_perm_b32 v17, v36, v36, v5
    v_perm_b32 v18, v36, v36, v6
    v_perm_b32 v19, v36, v36, v7
    buffer_load_dwordx4 v[88:91], v2, s[12:15], s63 offen offset:2560 nt
    s_waitcnt vmcnt(6)
    v_mfma_f32_16x16x32_bf16 v[32:35], v[12:15], v[124:127], v[32:35]
    buffer_load_dwordx4 v[92:95], v2, s[12:15], s63 offen offset:2688 nt
    s_waitcnt vmcnt(6)
    v_mfma_f32_16x16x32_bf16 v[24:27], v[16:19], v[68:71], v[24:27]
    v_mov_b32_dpp v36, v47 row_newbcast:6 row_mask:0xf bank_mask:0xf
    v_perm_b32 v12, v36, v36, v4
    buffer_load_dwordx4 v[96:99], v2, s[12:15], s63 offen offset:2816 nt
    s_waitcnt vmcnt(6)
    v_mfma_f32_16x16x32_bf16 v[28:31], v[16:19], v[72:75], v[28:31]
    v_perm_b32 v13, v36, v36, v5
    v_perm_b32 v14, v36, v36, v6
    v_perm_b32 v15, v36, v36, v7
    buffer_load_dwordx4 v[100:103], v2, s[12:15], s63 offen offset:2944 nt
    s_waitcnt vmcnt(6)
    v_mfma_f32_16x16x32_bf16 v[32:35], v[16:19], v[76:79], v[32:35]
    s_waitcnt vmcnt(5)
    v_mfma_f32_16x16x32_bf16 v[24:27], v[12:15], v[80:83], v[24:27]
    v_mov_b32_dpp v36, v47 row_newbcast:7 row_mask:0xf bank_mask:0xf
    v_perm_b32 v16, v36, v36, v4
    s_waitcnt vmcnt(4)
    v_mfma_f32_16x16x32_bf16 v[28:31], v[12:15], v[84:87], v[28:31]
    v_perm_b32 v17, v36, v36, v5
    v_perm_b32 v18, v36, v36, v6
    v_perm_b32 v19, v36, v36, v7
    s_waitcnt vmcnt(3)
    v_mfma_f32_16x16x32_bf16 v[32:35], v[12:15], v[88:91], v[32:35]
    s_waitcnt vmcnt(2)
    v_mfma_f32_16x16x32_bf16 v[24:27], v[16:19], v[92:95], v[24:27]
    s_waitcnt vmcnt(1)
    v_mfma_f32_16x16x32_bf16 v[28:31], v[16:19], v[96:99], v[28:31]
    s_waitcnt vmcnt(0)
    v_mfma_f32_16x16x32_bf16 v[32:35], v[16:19], v[100:103], v[32:35]
    s_nop 7
    s_call_b64 s[70:71], Lepi
    s_mov_b32 s81, s4
    s_cmp_eq_u32 s7, 1
    s_cbranch_scc1 LQ_6
    s_cmp_lg_u32 s7, 0
    s_cbranch_scc1 Ls_8
    s_call_b64 s[70:71], LpollA
Ls_8:
    s_cmp_lg_u32 s7, 0
    s_cbranch_scc1 Ls_9
    s_call_b64 s[70:71], Loproj
    s_barrier
Ls_9:
    s_add_u32 m0, s80, 65536
    s_add_u32 s60, s58, 21760
    buffer_load_dwordx4 v1, s[16:19], s60 offen nt lds
    s_waitcnt vmcnt(7)
    s_add_u32 m0, s80, 69632
    s_add_u32 s60, s58, 21632
    buffer_load_dwordx4 v1, s[16:19], s60 offen nt lds
    s_waitcnt vmcnt(7)
    s_add_u32 m0, s80, 73728
    s_add_u32 s60, s58, 21504
    buffer_load_dwordx4 v1, s[16:19], s60 offen nt lds
    s_waitcnt vmcnt(7)
    s_add_u32 m0, s80, 77824
    s_add_u32 s60, s58, 15616
    buffer_load_dwordx4 v1, s[16:19], s60 offen nt lds
    s_waitcnt vmcnt(7)
    s_add_u32 m0, s80, 81920
    s_add_u32 s60, s58, 15488
    buffer_load_dwordx4 v1, s[16:19], s60 offen nt lds
    s_waitcnt vmcnt(7)
    s_add_u32 m0, s80, 86016
    s_add_u32 s60, s58, 15360
    buffer_load_dwordx4 v1, s[16:19], s60 offen nt lds
    s_waitcnt vmcnt(7)
    s_add_u32 m0, s80, 90112
    s_add_u32 s60, s58, 9472
    buffer_load_dwordx4 v1, s[16:19], s60 offen nt lds
    s_waitcnt vmcnt(7)
    s_add_u32 m0, s80, 94208
    s_add_u32 s60, s58, 9344
    buffer_load_dwordx4 v1, s[16:19], s60 offen nt lds
    s_waitcnt vmcnt(7)
    s_add_u32 m0, s80, 98304
    s_add_u32 s60, s58, 9216
    buffer_load_dwordx4 v1, s[16:19], s60 offen nt lds
    s_waitcnt vmcnt(7)
    s_add_u32 m0, s80, 102400
    s_add_u32 s60, s58, 3328
    buffer_load_dwordx4 v1, s[16:19], s60 offen nt lds
    s_waitcnt vmcnt(7)
    s_branch LJ_7
LQ_6:
    v_lshrrev_b32 v19, 9, v0
    v_mul_u32_u24 v19, 12320, v19
    v_and_b32 v18, 0x1f0, v0
    v_xor_b32 v18, v18, v19
    v_xor_b32 v19, 64, v18
    s_mul_i32 s64, s4, 393216
    s_lshl_b32 m0, s4, 14
    s_nop 0
    buffer_load_dwordx4 v18, s[28:31], s64 offen nt lds
    s_waitcnt vmcnt(7)
    s_add_u32 m0, m0, 1024
    s_add_u32 s64, s64, 24576
    buffer_load_dwordx4 v19, s[28:31], s64 offen nt lds
    s_waitcnt vmcnt(7)
    s_add_u32 m0, m0, 1024
    s_add_u32 s64, s64, 24576
    buffer_load_dwordx4 v18, s[28:31], s64 offen nt lds
    s_waitcnt vmcnt(7)
    s_add_u32 m0, m0, 1024
    s_add_u32 s64, s64, 24576
    buffer_load_dwordx4 v19, s[28:31], s64 offen nt lds
    s_waitcnt vmcnt(7)
    s_add_u32 m0, m0, 1024
    s_add_u32 s64, s64, 24576
    v_xor_b32 v18, 128, v18
    v_xor_b32 v19, 128, v19
    buffer_load_dwordx4 v18, s[28:31], s64 offen nt lds
    s_waitcnt vmcnt(7)
    s_add_u32 m0, m0, 1024
    s_add_u32 s64, s64, 24576
    buffer_load_dwordx4 v19, s[28:31], s64 offen nt lds
    s_waitcnt vmcnt(7)
    s_add_u32 m0, m0, 1024
    s_add_u32 s64, s64, 24576
    buffer_load_dwordx4 v18, s[28:31], s64 offen nt lds
    s_waitcnt vmcnt(7)
    s_add_u32 m0, m0, 1024
    s_add_u32 s64, s64, 24576
    buffer_load_dwordx4 v19, s[28:31], s64 offen nt lds
    s_waitcnt vmcnt(7)
    s_add_u32 m0, m0, 1024
    s_add_u32 s64, s64, 24576
    v_xor_b32 v18, 128, v18
    v_xor_b32 v19, 128, v19
    buffer_load_dwordx4 v18, s[28:31], s64 offen nt lds
    s_waitcnt vmcnt(7)
    s_add_u32 m0, m0, 1024
    s_add_u32 s64, s64, 24576
    buffer_load_dwordx4 v19, s[28:31], s64 offen nt lds
    s_waitcnt vmcnt(7)
    s_add_u32 m0, m0, 1024
    s_add_u32 s64, s64, 24576
    buffer_load_dwordx4 v18, s[28:31], s64 offen nt lds
    s_waitcnt vmcnt(7)
    s_add_u32 m0, m0, 1024
    s_add_u32 s64, s64, 24576
    buffer_load_dwordx4 v19, s[28:31], s64 offen nt lds
    s_waitcnt vmcnt(7)
    s_add_u32 m0, m0, 1024
    s_add_u32 s64, s64, 24576
    v_xor_b32 v18, 128, v18
    v_xor_b32 v19, 128, v19
    buffer_load_dwordx4 v18, s[28:31], s64 offen nt lds
    s_waitcnt vmcnt(7)
    s_add_u32 m0, m0, 1024
    s_add_u32 s64, s64, 24576
    buffer_load_dwordx4 v19, s[28:31], s64 offen nt lds
    s_waitcnt vmcnt(7)
    s_add_u32 m0, m0, 1024
    s_add_u32 s64, s64, 24576
    buffer_load_dwordx4 v18, s[28:31], s64 offen nt lds
    s_waitcnt vmcnt(7)
    s_add_u32 m0, m0, 1024
    s_add_u32 s64, s64, 24576
    buffer_load_dwordx4 v19, s[28:31], s64 offen nt lds
    s_waitcnt vmcnt(7)
    s_add_u32 m0, s80, 65536
    s_add_u32 s60, s58, 21760
    buffer_load_dwordx4 v1, s[16:19], s60 offen nt lds
    s_waitcnt vmcnt(7)
    s_add_u32 m0, s80, 69632
    s_add_u32 s60, s58, 21632
    buffer_load_dwordx4 v1, s[16:19], s60 offen nt lds
    s_waitcnt vmcnt(7)
    s_add_u32 m0, s80, 73728
    s_add_u32 s60, s58, 21504
    buffer_load_dwordx4 v1, s[16:19], s60 offen nt lds
    s_waitcnt vmcnt(7)
    s_add_u32 m0, s80, 77824
    s_add_u32 s60, s58, 15616
    buffer_load_dwordx4 v1, s[16:19], s60 offen nt lds
    s_waitcnt vmcnt(7)
    s_add_u32 m0, s80, 81920
    s_add_u32 s60, s58, 15488
    buffer_load_dwordx4 v1, s[16:19], s60 offen nt lds
    s_waitcnt vmcnt(7)
    s_add_u32 m0, s80, 86016
    s_add_u32 s60, s58, 15360
    buffer_load_dwordx4 v1, s[16:19], s60 offen nt lds
    s_waitcnt vmcnt(7)
    s_add_u32 m0, s80, 90112
    s_add_u32 s60, s58, 9472
    buffer_load_dwordx4 v1, s[16:19], s60 offen nt lds
    s_waitcnt vmcnt(7)
    s_add_u32 m0, s80, 94208
    s_add_u32 s60, s58, 9344
    buffer_load_dwordx4 v1, s[16:19], s60 offen nt lds
    s_waitcnt vmcnt(7)
    s_add_u32 m0, s80, 98304
    s_add_u32 s60, s58, 9216
    buffer_load_dwordx4 v1, s[16:19], s60 offen nt lds
    s_waitcnt vmcnt(7)
    s_add_u32 m0, s80, 102400
    s_add_u32 s60, s58, 3328
    buffer_load_dwordx4 v1, s[16:19], s60 offen nt lds
    s_waitcnt vmcnt(7)
    s_call_b64 s[70:71], LpollB
    s_call_b64 s[72:73], Lqproj
    s_barrier
LJ_7:
    s_add_u32 m0, s80, 0
    s_add_u32 s60, s58, 3200
    buffer_load_dwordx4 v1, s[16:19], s60 offen nt lds
    s_waitcnt vmcnt(7)
    s_add_u32 m0, s80, 4096
    s_add_u32 s60, s58, 3072
    buffer_load_dwordx4 v1, s[16:19], s60 offen nt lds
    s_waitcnt vmcnt(7)
    s_add_u32 m0, s80, 8192
    s_add_u32 s60, s58, 18688
    buffer_load_dwordx4 v1, s[16:19], s60 offen nt lds
    s_waitcnt vmcnt(7)
    s_add_u32 m0, s80, 12288
    s_add_u32 s60, s58, 18560
    buffer_load_dwordx4 v1, s[16:19], s60 offen nt lds
    s_waitcnt vmcnt(7)
    s_add_u32 m0, s80, 16384
    s_add_u32 s60, s58, 18432
    buffer_load_dwordx4 v1, s[16:19], s60 offen nt lds
    s_waitcnt vmcnt(7)
    s_add_u32 m0, s80, 20480
    s_add_u32 s60, s58, 12544
    buffer_load_dwordx4 v1, s[16:19], s60 offen nt lds
    s_waitcnt vmcnt(7)
    s_cmp_lg_u32 s81, 0
    s_cbranch_scc1 Ls_10
    s_call_b64 s[70:71], Lcissue
Ls_10:
    s_cmp_lg_u32 s81, 0
    s_cbranch_scc1 Ls_11
    s_add_u32 m0, s80, 24576
    s_add_u32 s60, s58, 12416
    buffer_load_dwordx4 v1, s[16:19], s60 offen nt lds
    s_waitcnt vmcnt(17)
    s_add_u32 m0, s80, 28672
    s_add_u32 s60, s58, 12288
    buffer_load_dwordx4 v1, s[16:19], s60 offen nt lds
    s_waitcnt vmcnt(17)
    s_add_u32 m0, s80, 32768
    s_add_u32 s60, s58, 6400
    buffer_load_dwordx4 v1, s[16:19], s60 offen nt lds
    s_waitcnt vmcnt(17)
    s_add_u32 m0, s80, 36864
    s_add_u32 s60, s58, 6272
    buffer_load_dwordx4 v1, s[16:19], s60 offen nt lds
    s_waitcnt vmcnt(17)
    s_add_u32 m0, s80, 40960
    s_add_u32 s60, s58, 6144
    buffer_load_dwordx4 v1, s[16:19], s60 offen nt lds
    s_waitcnt vmcnt(17)
    s_add_u32 m0, s80, 45056
    s_add_u32 s60, s58, 256
    buffer_load_dwordx4 v1, s[16:19], s60 offen nt lds
    s_waitcnt vmcnt(17)
    s_waitcnt vmcnt(6)
    s_mov_b32 s35, 1
    s_call_b64 s[72:73], Lccheck
    s_mov_b32 s35, 0
    s_branch Ls_12
Ls_11:
    s_add_u32 m0, s80, 24576
    s_add_u32 s60, s58, 12416
    buffer_load_dwordx4 v1, s[16:19], s60 offen nt lds
    s_waitcnt vmcnt(7)
    s_add_u32 m0, s80, 28672
    s_add_u32 s60, s58, 12288
    buffer_load_dwordx4 v1, s[16:19], s60 offen nt lds
    s_waitcnt vmcnt(7)
    s_add_u32 m0, s80, 32768
    s_add_u32 s60, s58, 6400
    buffer_load_dwordx4 v1, s[16:19], s60 offen nt lds
    s_waitcnt vmcnt(7)
    s_add_u32 m0, s80, 36864
    s_add_u32 s60, s58, 6272
    buffer_load_dwordx4 v1, s[16:19], s60 offen nt lds
    s_waitcnt vmcnt(7)
    s_add_u32 m0, s80, 40960
    s_add_u32 s60, s58, 6144
    buffer_load_dwordx4 v1, s[16:19], s60 offen nt lds
    s_waitcnt vmcnt(7)
    s_add_u32 m0, s80, 45056
    s_add_u32 s60, s58, 256
    buffer_load_dwordx4 v1, s[16:19], s60 offen nt lds
    s_waitcnt vmcnt(7)
Ls_12:
    s_add_u32 m0, s80, 49152
    s_add_u32 s60, s58, 128
    buffer_load_dwordx4 v1, s[16:19], s60 offen nt lds
    s_add_u32 m0, s80, 53248
    s_add_u32 s60, s58, 0
    buffer_load_dwordx4 v1, s[16:19], s60 offen nt lds
    s_add_u32 m0, s80, 57344
    s_add_u32 s60, s58, 0
    buffer_load_dwordx4 v2, s[20:23], s60 offen nt lds
    s_add_u32 m0, s80, 61440
    s_add_u32 s60, s58, 128
    buffer_load_dwordx4 v2, s[20:23], s60 offen nt lds
    s_cmp_lg_u32 s81, 0
    s_cbranch_scc1 Ls_13
    s_call_b64 s[72:73], Lcretry
Ls_13:
    s_add_u32 s5, s5, 1
    s_add_u32 s82, s82, 4
    s_barrier
    s_waitcnt vmcnt(2)
    v_lshrrev_b32 v40, 7, v0
    v_lshlrev_b32 v40, 4, v40
    v_add_u32 v40, 162560, v40
    ds_read_b128 v[12:15], v40 offset:0
    ds_read_b128 v[16:19], v40 offset:128
    ds_read_b128 v[20:23], v40 offset:256
    v_bfe_u32 v45, v0, 4, 3
    v_lshrrev_b32 v46, 7, v0
    v_bfe_u32 v47, v0, 5, 1
    v_lshlrev_b32 v46, 4, v46
    v_lshlrev_b32 v47, 6, v47
    v_xor_b32 v46, v46, v47
    v_lshl_add_u32 v45, v45, 7, v46
    v_add_u32 v45, s80, v45
    v_add_u32 v46, 0x10000, v45
    v_add_u32 v47, 0x20000, v45
    v_add_u32 v10, 0x10000, v3
    v_add_u32 v11, 0x20000, v3
    ds_read_b128 v[48:51], v45 offset:53248
    ds_read_b128 v[52:55], v45 offset:49152
    ds_read_b128 v[56:59], v45 offset:45056
    ds_read_b128 v[60:63], v45 offset:40960
    ds_read_b128 v[64:67], v45 offset:36864
    s_waitcnt lgkmcnt(4)
    v_mfma_f32_16x16x32_bf16 v[24:27], v[12:15], v[48:51], 0
    ds_read_b128 v[48:51], v45 offset:32768
    s_add_u32 m0, s80, 53248
    s_add_u32 s60, s58, 256
    buffer_load_dwordx4 v2, s[20:23], s60 offen nt lds
    s_waitcnt lgkmcnt(4)
    v_mfma_f32_16x16x32_bf16 v[24:27], v[16:19], v[52:55], v[24:27]
    ds_read_b128 v[52:55], v45 offset:28672
    s_add_u32 m0, s80, 49152
    s_add_u32 s60, s58, 384
    buffer_load_dwordx4 v2, s[20:23], s60 offen nt lds
    s_waitcnt lgkmcnt(4)
    v_mfma_f32_16x16x32_bf16 v[24:27], v[20:23], v[56:59], v[24:27]
    ds_read_b128 v[56:59], v45 offset:24576
    s_add_u32 m0, s80, 45056
    s_add_u32 s60, s58, 512
    buffer_load_dwordx4 v2, s[20:23], s60 offen nt lds
    s_waitcnt lgkmcnt(4)
    v_mfma_f32_16x16x32_bf16 v[28:31], v[12:15], v[60:63], 0
    ds_read_b128 v[60:63], v45 offset:20480
    s_add_u32 m0, s80, 40960
    s_add_u32 s60, s58, 640
    buffer_load_dwordx4 v2, s[20:23], s60 offen nt lds
    s_waitcnt lgkmcnt(4)
    v_mfma_f32_16x16x32_bf16 v[28:31], v[16:19], v[64:67], v[28:31]
    ds_read_b128 v[64:67], v45 offset:16384
    s_add_u32 m0, s80, 36864
    s_add_u32 s60, s58, 768
    buffer_load_dwordx4 v2, s[20:23], s60 offen nt lds
    s_waitcnt lgkmcnt(4)
    v_mfma_f32_16x16x32_bf16 v[28:31], v[20:23], v[48:51], v[28:31]
    ds_read_b128 v[48:51], v45 offset:12288
    s_add_u32 m0, s80, 32768
    s_add_u32 s60, s58, 896
    buffer_load_dwordx4 v2, s[20:23], s60 offen nt lds
    s_waitcnt lgkmcnt(4)
    v_mfma_f32_16x16x32_bf16 v[32:35], v[12:15], v[52:55], 0
    ds_read_b128 v[52:55], v45 offset:8192
    s_add_u32 m0, s80, 28672
    s_add_u32 s60, s58, 1024
    buffer_load_dwordx4 v2, s[20:23], s60 offen nt lds
    s_waitcnt lgkmcnt(4)
    v_mfma_f32_16x16x32_bf16 v[32:35], v[16:19], v[56:59], v[32:35]
    ds_read_b128 v[56:59], v45 offset:4096
    s_add_u32 m0, s80, 24576
    s_add_u32 s60, s58, 1152
    buffer_load_dwordx4 v2, s[20:23], s60 offen nt lds
    s_waitcnt lgkmcnt(4)
    v_mfma_f32_16x16x32_bf16 v[32:35], v[20:23], v[60:63], v[32:35]
    ds_read_b128 v[60:63], v45 offset:0
    s_add_u32 m0, s80, 20480
    s_add_u32 s60, s58, 1280
    buffer_load_dwordx4 v2, s[20:23], s60 offen nt lds
    s_waitcnt lgkmcnt(4)
    v_mfma_f32_16x16x32_bf16 v[36:39], v[12:15], v[64:67], 0
    ds_read_b128 v[64:67], v46 offset:36864
    s_add_u32 m0, s80, 16384
    s_add_u32 s60, s58, 1408
    buffer_load_dwordx4 v2, s[20:23], s60 offen nt lds
    s_waitcnt lgkmcnt(4)
    v_mfma_f32_16x16x32_bf16 v[36:39], v[16:19], v[48:51], v[36:39]
    ds_read_b128 v[48:51], v46 offset:32768
    s_add_u32 m0, s80, 12288
    s_add_u32 s60, s58, 1536
    buffer_load_dwordx4 v2, s[20:23], s60 offen nt lds
    s_waitcnt lgkmcnt(4)
    v_mfma_f32_16x16x32_bf16 v[36:39], v[20:23], v[52:55], v[36:39]
    ds_read_b128 v[52:55], v46 offset:28672
    s_add_u32 m0, s80, 8192
    s_add_u32 s60, s58, 1664
    buffer_load_dwordx4 v2, s[20:23], s60 offen nt lds
    v_mov_b32 v40, v24
    s_waitcnt lgkmcnt(4)
    v_mfma_f32_16x16x32_bf16 v[24:27], v[12:15], v[56:59], 0
    ds_read_b128 v[56:59], v46 offset:24576
    s_waitcnt lgkmcnt(4)
    v_mfma_f32_16x16x32_bf16 v[24:27], v[16:19], v[60:63], v[24:27]
    ds_read_b128 v[60:63], v46 offset:20480
    s_waitcnt lgkmcnt(4)
    v_mfma_f32_16x16x32_bf16 v[24:27], v[20:23], v[64:67], v[24:27]
    ds_read_b128 v[64:67], v46 offset:16384
    s_add_u32 m0, s80, 102400
    s_add_u32 s60, s58, 1792
    buffer_load_dwordx4 v2, s[20:23], s60 offen nt lds
    v_mov_b32_dpp v40, v28 quad_perm:[0,1,2,3] row_mask:0xa bank_mask:0xf
    s_waitcnt lgkmcnt(4)
    v_mfma_f32_16x16x32_bf16 v[28:31], v[12:15], v[48:51], 0
    ds_read_b128 v[48:51], v46 offset:12288
    s_add_u32 m0, s80, 98304
    s_add_u32 s60, s58, 1920
    buffer_load_dwordx4 v2, s[20:23], s60 offen nt lds
    s_waitcnt lgkmcnt(4)
    v_mfma_f32_16x16x32_bf16 v[28:31], v[16:19], v[52:55], v[28:31]
    ds_read_b128 v[52:55], v46 offset:8192
    s_add_u32 m0, s80, 94208
    s_add_u32 s60, s58, 2048
    buffer_load_dwordx4 v2, s[20:23], s60 offen nt lds
    s_waitcnt lgkmcnt(4)
    v_mfma_f32_16x16x32_bf16 v[28:31], v[20:23], v[56:59], v[28:31]
    ds_read_b128 v[56:59], v46 offset:4096
    s_add_u32 m0, s80, 90112
    s_add_u32 s60, s58, 2176
    buffer_load_dwordx4 v2, s[20:23], s60 offen nt lds
    v_mov_b32 v41, v32
    s_waitcnt lgkmcnt(4)
    v_mfma_f32_16x16x32_bf16 v[32:35], v[12:15], v[60:63], 0
    ds_read_b128 v[60:63], v46 offset:0
    s_add_u32 m0, s80, 86016
    s_add_u32 s60, s58, 2304
    buffer_load_dwordx4 v2, s[20:23], s60 offen nt lds
    s_waitcnt lgkmcnt(4)
    v_mfma_f32_16x16x32_bf16 v[32:35], v[16:19], v[64:67], v[32:35]
    s_add_u32 m0, s80, 81920
    s_add_u32 s60, s58, 2432
    buffer_load_dwordx4 v2, s[20:23], s60 offen nt lds
    s_waitcnt lgkmcnt(3)
    v_mfma_f32_16x16x32_bf16 v[32:35], v[20:23], v[48:51], v[32:35]
    s_add_u32 m0, s80, 77824
    s_add_u32 s60, s58, 2560
    buffer_load_dwordx4 v2, s[20:23], s60 offen nt lds
    v_mov_b32_dpp v41, v36 quad_perm:[0,1,2,3] row_mask:0xa bank_mask:0xf
    s_waitcnt lgkmcnt(2)
    v_mfma_f32_16x16x32_bf16 v[36:39], v[12:15], v[52:55], 0
    s_add_u32 m0, s80, 73728
    s_add_u32 s60, s58, 2688
    buffer_load_dwordx4 v2, s[20:23], s60 offen nt lds
    s_waitcnt lgkmcnt(1)
    v_mfma_f32_16x16x32_bf16 v[36:39], v[16:19], v[56:59], v[36:39]
    s_add_u32 m0, s80, 69632
    s_add_u32 s60, s58, 2816
    buffer_load_dwordx4 v2, s[20:23], s60 offen nt lds
    v_permlane32_swap_b32 v40, v41
    s_waitcnt lgkmcnt(0)
    v_mfma_f32_16x16x32_bf16 v[36:39], v[20:23], v[60:63], v[36:39]
    s_add_u32 m0, s80, 65536
    s_add_u32 s60, s58, 2944
    buffer_load_dwordx4 v2, s[20:23], s60 offen nt lds
    v_add_f32_dpp v44, v41, v40 row_ror:8 row_mask:0xf bank_mask:0x3
    v_mov_b32 v42, v24
    s_nop 1
    v_mov_b32_dpp v42, v28 quad_perm:[0,1,2,3] row_mask:0xa bank_mask:0xf
    v_mov_b32 v43, v32
    s_nop 1
    v_mov_b32_dpp v43, v36 quad_perm:[0,1,2,3] row_mask:0xa bank_mask:0xf
    s_nop 1
    v_permlane32_swap_b32 v42, v43
    s_nop 1
    v_add_f32_dpp v44, v42, v43 row_ror:8 row_mask:0xf bank_mask:0xc
    s_nop 1
    v_max_f32_dpp v39, v44, v44 row_ror:8 row_mask:0xf bank_mask:0xf
    v_mov_b32 v38, s82
    s_nop 0
    v_max_f32_dpp v39, v39, v39 row_ror:4 row_mask:0xf bank_mask:0xf
    s_nop 1
    v_max_f32_dpp v39, v39, v39 row_ror:2 row_mask:0xf bank_mask:0xf
    s_nop 1
    v_max_f32_dpp v39, v39, v39 row_ror:1 row_mask:0xf bank_mask:0xf
    s_mov_b32 exec_lo, 0x10001
    s_mov_b32 exec_hi, 0x10001
    ds_max_f32 v38, v39
    s_mov_b64 exec, -1
    s_waitcnt lgkmcnt(0)
    s_barrier
    ds_read_b32 v39, v38
    s_waitcnt lgkmcnt(0)
    v_mul_f32 v39, s84, v39
    v_fma_f32 v44, v44, s84, -v39
    v_exp_f32 v44, v44
    s_nop 1
    v_mov_b32_dpp v40, v44 row_ror:8 row_mask:0xf bank_mask:0xf
    v_mov_b32 v38, v44
    v_cvt_pk_bf16_f32 v44, v44, v40
    s_nop 0
    v_add_f32_dpp v38, v38, v38 row_ror:8 row_mask:0xf bank_mask:0xf
    s_nop 1
    v_add_f32_dpp v38, v38, v38 row_ror:4 row_mask:0xf bank_mask:0xf
    s_nop 1
    v_add_f32_dpp v38, v38, v38 row_ror:2 row_mask:0xf bank_mask:0xf
    s_nop 1
    v_add_f32_dpp v38, v38, v38 row_ror:1 row_mask:0xf bank_mask:0xf
    v_mov_b32 v37, v38
    s_nop 1
    v_permlane32_swap_b32 v38, v37
    v_add_f32 v38, v38, v37
    v_mov_b32 v37, v38
    s_nop 1
    v_permlane16_swap_b32 v38, v37
    v_add_f32 v38, v38, v37
    s_lshl_b32 s60, s4, 2
    s_add_u32 s60, s60, 162960
    v_mov_b32 v37, s60
    s_mov_b64 exec, 1
    ds_write_b32 v37, v38
    s_mov_b64 exec, -1
    s_waitcnt vmcnt(22)
    ds_read_b128 v[48:51], v3 offset:57344
    ds_read_b128 v[52:55], v3 offset:61440
    s_waitcnt vmcnt(21)
    ds_read_b128 v[56:59], v3 offset:53248
    s_waitcnt vmcnt(20)
    ds_read_b128 v[60:63], v3 offset:49152
    s_waitcnt vmcnt(19)
    ds_read_b128 v[64:67], v3 offset:45056
    s_waitcnt vmcnt(18)
    ds_read_b128 v[20:23], v3 offset:40960
    s_waitcnt vmcnt(17)
    ds_read_b128 v[40:43], v3 offset:36864
    v_mov_b32_dpp v36, v44 row_newbcast:0 row_mask:0xf bank_mask:0xf
    v_perm_b32 v12, v36, v36, v4
    v_perm_b32 v13, v36, v36, v5
    v_perm_b32 v14, v36, v36, v6
    v_perm_b32 v15, v36, v36, v7
    s_waitcnt lgkmcnt(6)
    s_nop 0
    v_mfma_f32_16x16x32_bf16 v[24:27], v[12:15], v[48:51], 0
    v_mov_b32_dpp v36, v44 row_newbcast:1 row_mask:0xf bank_mask:0xf
    v_perm_b32 v16, v36, v36, v4
    s_waitcnt vmcnt(16)
    ds_read_b128 v[48:51], v3 offset:32768
    s_waitcnt lgkmcnt(6)
    v_mfma_f32_16x16x32_bf16 v[28:31], v[12:15], v[52:55], 0
    v_perm_b32 v17, v36, v36, v5
    v_perm_b32 v18, v36, v36, v6
    v_perm_b32 v19, v36, v36, v7
    s_waitcnt vmcnt(15)
    ds_read_b128 v[52:55], v3 offset:28672
    s_waitcnt lgkmcnt(6)
    v_mfma_f32_16x16x32_bf16 v[32:35], v[12:15], v[56:59], 0
    s_waitcnt vmcnt(14)
    ds_read_b128 v[56:59], v3 offset:24576
    s_waitcnt lgkmcnt(6)
    v_mfma_f32_16x16x32_bf16 v[24:27], v[16:19], v[60:63], v[24:27]
    v_mov_b32_dpp v36, v44 row_newbcast:2 row_mask:0xf bank_mask:0xf
    v_perm_b32 v12, v36, v36, v4
    s_waitcnt vmcnt(13)
    ds_read_b128 v[60:63], v3 offset:20480
    s_waitcnt lgkmcnt(6)
    v_mfma_f32_16x16x32_bf16 v[28:31], v[16:19], v[64:67], v[28:31]
    v_perm_b32 v13, v36, v36, v5
    v_perm_b32 v14, v36, v36, v6
    v_perm_b32 v15, v36, v36, v7
    s_waitcnt vmcnt(12)
    ds_read_b128 v[64:67], v3 offset:16384
    s_waitcnt lgkmcnt(6)
    v_mfma_f32_16x16x32_bf16 v[32:35], v[16:19], v[20:23], v[32:35]
    s_waitcnt vmcnt(11)
    ds_read_b128 v[20:23], v3 offset:12288
    s_waitcnt lgkmcnt(6)
    v_mfma_f32_16x16x32_bf16 v[24:27], v[12:15], v[40:43], v[24:27]
    v_mov_b32_dpp v36, v44 row_newbcast:3 row_mask:0xf bank_mask:0xf
    v_perm_b32 v16, v36, v36, v4
    s_waitcnt vmcnt(10)
    ds_read_b128 v[40:43], v3 offset:8192
    s_waitcnt lgkmcnt(6)
    v_mfma_f32_16x16x32_bf16 v[28:31], v[12:15], v[48:51], v[28:31]
    v_perm_b32 v17, v36, v36, v5
    v_perm_b32 v18, v36, v36, v6
    v_perm_b32 v19, v36, v36, v7
    s_waitcnt lgkmcnt(5)
    v_mfma_f32_16x16x32_bf16 v[32:35], v[12:15], v[52:55], v[32:35]
    s_waitcnt lgkmcnt(4)
    v_mfma_f32_16x16x32_bf16 v[24:27], v[16:19], v[56:59], v[24:27]
    v_mov_b32_dpp v36, v44 row_newbcast:4 row_mask:0xf bank_mask:0xf
    v_perm_b32 v12, v36, v36, v4
    s_waitcnt lgkmcnt(3)
    v_mfma_f32_16x16x32_bf16 v[28:31], v[16:19], v[60:63], v[28:31]
    v_perm_b32 v13, v36, v36, v5
    v_perm_b32 v14, v36, v36, v6
    v_perm_b32 v15, v36, v36, v7
    s_waitcnt lgkmcnt(2)
    v_mfma_f32_16x16x32_bf16 v[32:35], v[16:19], v[64:67], v[32:35]
    s_waitcnt lgkmcnt(0)
    s_barrier
    s_cmp_lg_u32 s7, 0
    s_cbranch_scc1 Ls_14
    v_lshrrev_b32 v38, 7, v0
    v_mul_u32_u24 v38, 1280, v38
    v_and_b32 v37, 0x70, v0
    v_or_b32 v37, v37, v38
    v_bfe_u32 v38, v0, 8, 1
    v_lshlrev_b32 v38, 5, v38
    v_xor_b32 v37, v37, v38
    v_xor_b32 v38, 64, v37
    s_lshr_b32 s64, s4, 1
    s_lshl_b32 s64, s64, 7
    s_mul_i32 s65, s75, 163840
    s_add_u32 s64, s64, s65
    s_lshl_b32 m0, s4, 14
    s_nop 0
    buffer_load_dwordx4 v37, s[28:31], s64 offen nt lds
    s_add_u32 m0, m0, 1024
    s_add_u32 s64, s64, 10240
    buffer_load_dwordx4 v38, s[28:31], s64 offen nt lds
    s_add_u32 m0, m0, 1024
    s_add_u32 s64, s64, 10240
    buffer_load_dwordx4 v37, s[28:31], s64 offen nt lds
    s_add_u32 m0, m0, 1024
    s_add_u32 s64, s64, 10240
    buffer_load_dwordx4 v38, s[28:31], s64 offen nt lds
    s_add_u32 m0, m0, 1024
    s_add_u32 s64, s64, 10240
    buffer_load_dwordx4 v37, s[28:31], s64 offen nt lds
    s_add_u32 m0, m0, 1024
    s_add_u32 s64, s64, 10240
    buffer_load_dwordx4 v38, s[28:31], s64 offen nt lds
    s_add_u32 m0, m0, 1024
    s_add_u32 s64, s64, 10240
    buffer_load_dwordx4 v37, s[28:31], s64 offen nt lds
    s_add_u32 m0, m0, 1024
    s_add_u32 s64, s64, 10240
    buffer_load_dwordx4 v38, s[28:31], s64 offen nt lds
    s_add_u32 m0, m0, 1024
    s_add_u32 s64, s64, 10240
    buffer_load_dwordx4 v37, s[28:31], s64 offen nt lds
    s_add_u32 m0, m0, 1024
    s_add_u32 s64, s64, 10240
    buffer_load_dwordx4 v38, s[28:31], s64 offen nt lds
    s_add_u32 m0, m0, 1024
    s_add_u32 s64, s64, 10240
    buffer_load_dwordx4 v37, s[28:31], s64 offen nt lds
    s_add_u32 m0, m0, 1024
    s_add_u32 s64, s64, 10240
    buffer_load_dwordx4 v38, s[28:31], s64 offen nt lds
    s_add_u32 m0, m0, 1024
    s_add_u32 s64, s64, 10240
    buffer_load_dwordx4 v37, s[28:31], s64 offen nt lds
    s_add_u32 m0, m0, 1024
    s_add_u32 s64, s64, 10240
    buffer_load_dwordx4 v38, s[28:31], s64 offen nt lds
    s_add_u32 m0, m0, 1024
    s_add_u32 s64, s64, 10240
    buffer_load_dwordx4 v37, s[28:31], s64 offen nt lds
    s_add_u32 m0, m0, 1024
    s_add_u32 s64, s64, 10240
    buffer_load_dwordx4 v38, s[28:31], s64 offen nt lds
    s_waitcnt vmcnt(16)
    s_branch Ls_16
Ls_14:
    s_waitcnt vmcnt(0)
Ls_16:
    ds_read_b128 v[48:51], v10 offset:36864
    ds_read_b128 v[52:55], v10 offset:32768
    ds_read_b128 v[56:59], v10 offset:28672
    ds_read_b128 v[60:63], v10 offset:24576
    ds_read_b128 v[64:67], v10 offset:20480
    v_mfma_f32_16x16x32_bf16 v[24:27], v[12:15], v[20:23], v[24:27]
    v_mov_b32_dpp v36, v44 row_newbcast:5 row_mask:0xf bank_mask:0xf
    v_perm_b32 v16, v36, v36, v4
    ds_read_b128 v[20:23], v10 offset:16384
    v_mfma_f32_16x16x32_bf16 v[28:31], v[12:15], v[40:43], v[28:31]
    v_perm_b32 v17, v36, v36, v5
    v_perm_b32 v18, v36, v36, v6
    v_perm_b32 v19, v36, v36, v7
    ds_read_b128 v[40:43], v10 offset:12288
    s_waitcnt lgkmcnt(6)
    v_mfma_f32_16x16x32_bf16 v[32:35], v[12:15], v[48:51], v[32:35]
    ds_read_b128 v[48:51], v10 offset:8192
    s_waitcnt lgkmcnt(6)
    v_mfma_f32_16x16x32_bf16 v[24:27], v[16:19], v[52:55], v[24:27]
    v_mov_b32_dpp v36, v44 row_newbcast:6 row_mask:0xf bank_mask:0xf
    v_perm_b32 v12, v36, v36, v4
    ds_read_b128 v[52:55], v10 offset:4096
    s_waitcnt lgkmcnt(6)
    v_mfma_f32_16x16x32_bf16 v[28:31], v[16:19], v[56:59], v[28:31]
    v_perm_b32 v13, v36, v36, v5
    v_perm_b32 v14, v36, v36, v6
    v_perm_b32 v15, v36, v36, v7
    ds_read_b128 v[56:59], v10 offset:0
    s_waitcnt lgkmcnt(6)
    v_mfma_f32_16x16x32_bf16 v[32:35], v[16:19], v[60:63], v[32:35]
    s_waitcnt lgkmcnt(5)
    v_mfma_f32_16x16x32_bf16 v[24:27], v[12:15], v[64:67], v[24:27]
    v_mov_b32_dpp v36, v44 row_newbcast:7 row_mask:0xf bank_mask:0xf
    v_perm_b32 v16, v36, v36, v4
    s_waitcnt lgkmcnt(4)
    v_mfma_f32_16x16x32_bf16 v[28:31], v[12:15], v[20:23], v[28:31]
    v_perm_b32 v17, v36, v36, v5
    v_perm_b32 v18, v36, v36, v6
    v_perm_b32 v19, v36, v36, v7
    s_waitcnt lgkmcnt(3)
    v_mfma_f32_16x16x32_bf16 v[32:35], v[12:15], v[40:43], v[32:35]
    s_waitcnt lgkmcnt(2)
    v_mfma_f32_16x16x32_bf16 v[24:27], v[16:19], v[48:51], v[24:27]
    s_waitcnt lgkmcnt(1)
    v_mfma_f32_16x16x32_bf16 v[28:31], v[16:19], v[52:55], v[28:31]
    s_waitcnt lgkmcnt(0)
    v_mfma_f32_16x16x32_bf16 v[32:35], v[16:19], v[56:59], v[32:35]
    s_nop 7
    s_call_b64 s[70:71], Lepi
    s_mov_b32 s81, s4
    s_cmp_eq_u32 s7, 1
    s_cbranch_scc1 LQ_17
    s_cmp_lg_u32 s7, 0
    s_cbranch_scc1 Ls_19
    s_call_b64 s[70:71], LpollA
Ls_19:
    s_cmp_lg_u32 s7, 0
    s_cbranch_scc1 Ls_20
    s_call_b64 s[70:71], Loproj
    s_barrier
Ls_20:
    s_add_u32 m0, s80, 65536
    s_add_u32 s60, s57, 0
    buffer_load_dwordx4 v2, s[12:15], s60 offen nt lds
    s_waitcnt vmcnt(7)
    s_add_u32 m0, s80, 69632
    s_add_u32 s60, s57, 128
    buffer_load_dwordx4 v2, s[12:15], s60 offen nt lds
    s_waitcnt vmcnt(7)
    s_add_u32 m0, s80, 73728
    s_add_u32 s60, s57, 256
    buffer_load_dwordx4 v2, s[12:15], s60 offen nt lds
    s_waitcnt vmcnt(7)
    s_add_u32 m0, s80, 77824
    s_add_u32 s60, s57, 384
    buffer_load_dwordx4 v2, s[12:15], s60 offen nt lds
    s_waitcnt vmcnt(7)
    s_branch LJ_18
LQ_17:
    v_lshrrev_b32 v19, 9, v0
    v_mul_u32_u24 v19, 12320, v19
    v_and_b32 v18, 0x1f0, v0
    v_xor_b32 v18, v18, v19
    v_xor_b32 v19, 64, v18
    s_mul_i32 s64, s4, 393216
    s_lshl_b32 m0, s4, 14
    s_nop 0
    buffer_load_dwordx4 v18, s[24:27], s64 offen nt lds
    s_waitcnt vmcnt(7)
    s_add_u32 m0, m0, 1024
    s_add_u32 s64, s64, 24576
    buffer_load_dwordx4 v19, s[24:27], s64 offen nt lds
    s_waitcnt vmcnt(7)
    s_add_u32 m0, m0, 1024
    s_add_u32 s64, s64, 24576
    buffer_load_dwordx4 v18, s[24:27], s64 offen nt lds
    s_waitcnt vmcnt(7)
    s_add_u32 m0, m0, 1024
    s_add_u32 s64, s64, 24576
    buffer_load_dwordx4 v19, s[24:27], s64 offen nt lds
    s_waitcnt vmcnt(7)
    s_add_u32 m0, m0, 1024
    s_add_u32 s64, s64, 24576
    v_xor_b32 v18, 128, v18
    v_xor_b32 v19, 128, v19
    buffer_load_dwordx4 v18, s[24:27], s64 offen nt lds
    s_waitcnt vmcnt(7)
    s_add_u32 m0, m0, 1024
    s_add_u32 s64, s64, 24576
    buffer_load_dwordx4 v19, s[24:27], s64 offen nt lds
    s_waitcnt vmcnt(7)
    s_add_u32 m0, m0, 1024
    s_add_u32 s64, s64, 24576
    buffer_load_dwordx4 v18, s[24:27], s64 offen nt lds
    s_waitcnt vmcnt(7)
    s_add_u32 m0, m0, 1024
    s_add_u32 s64, s64, 24576
    buffer_load_dwordx4 v19, s[24:27], s64 offen nt lds
    s_waitcnt vmcnt(7)
    s_add_u32 m0, m0, 1024
    s_add_u32 s64, s64, 24576
    v_xor_b32 v18, 128, v18
    v_xor_b32 v19, 128, v19
    buffer_load_dwordx4 v18, s[24:27], s64 offen nt lds
    s_waitcnt vmcnt(7)
    s_add_u32 m0, m0, 1024
    s_add_u32 s64, s64, 24576
    buffer_load_dwordx4 v19, s[24:27], s64 offen nt lds
    s_waitcnt vmcnt(7)
    s_add_u32 m0, m0, 1024
    s_add_u32 s64, s64, 24576
    buffer_load_dwordx4 v18, s[24:27], s64 offen nt lds
    s_waitcnt vmcnt(7)
    s_add_u32 m0, m0, 1024
    s_add_u32 s64, s64, 24576
    buffer_load_dwordx4 v19, s[24:27], s64 offen nt lds
    s_waitcnt vmcnt(7)
    s_add_u32 m0, m0, 1024
    s_add_u32 s64, s64, 24576
    v_xor_b32 v18, 128, v18
    v_xor_b32 v19, 128, v19
    buffer_load_dwordx4 v18, s[24:27], s64 offen nt lds
    s_waitcnt vmcnt(7)
    s_add_u32 m0, m0, 1024
    s_add_u32 s64, s64, 24576
    buffer_load_dwordx4 v19, s[24:27], s64 offen nt lds
    s_waitcnt vmcnt(7)
    s_add_u32 m0, m0, 1024
    s_add_u32 s64, s64, 24576
    buffer_load_dwordx4 v18, s[24:27], s64 offen nt lds
    s_waitcnt vmcnt(7)
    s_add_u32 m0, m0, 1024
    s_add_u32 s64, s64, 24576
    buffer_load_dwordx4 v19, s[24:27], s64 offen nt lds
    s_waitcnt vmcnt(7)
    s_add_u32 m0, s80, 65536
    s_add_u32 s60, s57, 0
    buffer_load_dwordx4 v2, s[12:15], s60 offen nt lds
    s_waitcnt vmcnt(7)
    s_add_u32 m0, s80, 69632
    s_add_u32 s60, s57, 128
    buffer_load_dwordx4 v2, s[12:15], s60 offen nt lds
    s_waitcnt vmcnt(7)
    s_add_u32 m0, s80, 73728
    s_add_u32 s60, s57, 256
    buffer_load_dwordx4 v2, s[12:15], s60 offen nt lds
    s_waitcnt vmcnt(7)
    s_add_u32 m0, s80, 77824
    s_add_u32 s60, s57, 384
    buffer_load_dwordx4 v2, s[12:15], s60 offen nt lds
    s_waitcnt vmcnt(7)
    s_waitcnt vmcnt(4)
    s_call_b64 s[70:71], LpollB
    s_call_b64 s[72:73], Lqproj
    s_barrier
LJ_18:
    s_add_u32 m0, s80, 81920
    s_add_u32 s60, s57, 512
    buffer_load_dwordx4 v2, s[12:15], s60 offen nt lds
    s_waitcnt vmcnt(7)
    s_add_u32 m0, s80, 86016
    s_add_u32 s60, s57, 640
    buffer_load_dwordx4 v2, s[12:15], s60 offen nt lds
    s_waitcnt vmcnt(7)
    s_add_u32 m0, s80, 90112
    s_add_u32 s60, s57, 768
    buffer_load_dwordx4 v2, s[12:15], s60 offen nt lds
    s_waitcnt vmcnt(7)
    s_add_u32 m0, s80, 94208
    s_add_u32 s60, s57, 896
    buffer_load_dwordx4 v2, s[12:15], s60 offen nt lds
    s_waitcnt vmcnt(7)
    s_add_u32 m0, s80, 98304
    s_add_u32 s60, s57, 1024
    buffer_load_dwordx4 v2, s[12:15], s60 offen nt lds
    s_waitcnt vmcnt(7)
    s_add_u32 m0, s80, 102400
    s_add_u32 s60, s57, 1152
    buffer_load_dwordx4 v2, s[12:15], s60 offen nt lds
    s_waitcnt vmcnt(7)
    s_add_u32 m0, s80, 0
    s_add_u32 s60, s57, 1280
    buffer_load_dwordx4 v2, s[12:15], s60 offen nt lds
    s_waitcnt vmcnt(7)
    s_add_u32 m0, s80, 4096
    s_add_u32 s60, s57, 1408
    buffer_load_dwordx4 v2, s[12:15], s60 offen nt lds
    s_waitcnt vmcnt(7)
    s_add_u32 m0, s80, 8192
    s_add_u32 s60, s57, 1536
    buffer_load_dwordx4 v2, s[12:15], s60 offen nt lds
    s_waitcnt vmcnt(7)
    s_add_u32 m0, s80, 12288
    s_add_u32 s60, s57, 1664
    buffer_load_dwordx4 v2, s[12:15], s60 offen nt lds
    s_waitcnt vmcnt(7)
    s_add_u32 m0, s80, 16384
    s_add_u32 s60, s57, 1792
    buffer_load_dwordx4 v2, s[12:15], s60 offen nt lds
    s_waitcnt vmcnt(7)
    s_add_u32 m0, s80, 20480
    s_add_u32 s60, s57, 1920
    buffer_load_dwordx4 v2, s[12:15], s60 offen nt lds
    s_waitcnt vmcnt(7)
    s_add_u32 m0, s80, 24576
    s_add_u32 s60, s57, 2048
    buffer_load_dwordx4 v2, s[12:15], s60 offen nt lds
    s_waitcnt vmcnt(7)
    s_cmp_lg_u32 s81, 0
    s_cbranch_scc1 Ls_21
    s_call_b64 s[70:71], Lcissue
Ls_21:
    s_cmp_lg_u32 s81, 0
    s_cbranch_scc1 Ls_22
    s_add_u32 m0, s80, 28672
    s_add_u32 s60, s57, 2176
    buffer_load_dwordx4 v2, s[12:15], s60 offen nt lds
    s_waitcnt vmcnt(17)
    s_add_u32 m0, s80, 32768
    s_add_u32 s60, s57, 2304
    buffer_load_dwordx4 v2, s[12:15], s60 offen nt lds
    s_waitcnt vmcnt(17)
    s_add_u32 m0, s80, 36864
    s_add_u32 s60, s57, 2432
    buffer_load_dwordx4 v2, s[12:15], s60 offen nt lds
    s_waitcnt vmcnt(17)
    s_add_u32 m0, s80, 40960
    s_add_u32 s60, s57, 2560
    buffer_load_dwordx4 v2, s[12:15], s60 offen nt lds
    s_waitcnt vmcnt(17)
    s_add_u32 m0, s80, 45056
    s_add_u32 s60, s57, 2688
    buffer_load_dwordx4 v2, s[12:15], s60 offen nt lds
    s_waitcnt vmcnt(17)
    s_add_u32 m0, s80, 49152
    s_add_u32 s60, s57, 2816
    buffer_load_dwordx4 v2, s[12:15], s60 offen nt lds
    s_waitcnt vmcnt(17)
    s_waitcnt vmcnt(6)
    s_mov_b32 s35, 1
    s_call_b64 s[72:73], Lccheck
    s_mov_b32 s35, 0
    s_branch Ls_23
Ls_22:
    s_add_u32 m0, s80, 28672
    s_add_u32 s60, s57, 2176
    buffer_load_dwordx4 v2, s[12:15], s60 offen nt lds
    s_waitcnt vmcnt(7)
    s_add_u32 m0, s80, 32768
    s_add_u32 s60, s57, 2304
    buffer_load_dwordx4 v2, s[12:15], s60 offen nt lds
    s_waitcnt vmcnt(7)
    s_add_u32 m0, s80, 36864
    s_add_u32 s60, s57, 2432
    buffer_load_dwordx4 v2, s[12:15], s60 offen nt lds
    s_waitcnt vmcnt(7)
    s_add_u32 m0, s80, 40960
    s_add_u32 s60, s57, 2560
    buffer_load_dwordx4 v2, s[12:15], s60 offen nt lds
    s_waitcnt vmcnt(7)
    s_add_u32 m0, s80, 45056
    s_add_u32 s60, s57, 2688
    buffer_load_dwordx4 v2, s[12:15], s60 offen nt lds
    s_waitcnt vmcnt(7)
    s_add_u32 m0, s80, 49152
    s_add_u32 s60, s57, 2816
    buffer_load_dwordx4 v2, s[12:15], s60 offen nt lds
    s_waitcnt vmcnt(7)
Ls_23:
    s_add_u32 m0, s80, 53248
    s_add_u32 s60, s57, 2944
    buffer_load_dwordx4 v2, s[12:15], s60 offen nt lds
    s_add_u32 m0, s80, 57344
    s_add_u32 s60, s57, 24576
    buffer_load_dwordx4 v2, s[12:15], s60 offen nt lds
    s_add_u32 m0, s80, 61440
    s_add_u32 s60, s57, 24704
    buffer_load_dwordx4 v2, s[12:15], s60 offen nt lds
    s_add_u32 s60, s57, 24576
    buffer_load_dwordx4 v[64:67], v2, s[12:15], s60 offen offset:256 nt
    s_cmp_lg_u32 s81, 0
    s_cbranch_scc1 Ls_24
    s_call_b64 s[72:73], Lcretry
Ls_24:
    s_add_u32 s5, s5, 1
    s_add_u32 s82, s82, 4
    s_barrier
    s_call_b64 s[70:71], Lqka
    v_bfe_u32 v10, v0, 4, 3
    v_lshrrev_b32 v11, 7, v0
    v_mul_u32_u24 v1, 384, v10
    v_lshl_add_u32 v1, v11, 4, v1
    v_add_u32 v10, 0x10000, v3
    v_add_u32 v11, 0x20000, v3
    s_waitcnt vmcnt(9)
    ds_read_b128 a[228:231], v10 offset:0
    ds_read_b128 a[232:235], v10 offset:4096
    ds_read_b128 a[236:239], v10 offset:8192
    ds_read_b128 a[240:243], v10 offset:12288
    ds_read_b128 a[244:247], v10 offset:16384
    ds_read_b128 a[248:251], v10 offset:20480
    ds_read_b128 a[252:255], v10 offset:24576
    ds_read_b128 v[128:131], v10 offset:28672
    ds_read_b128 v[132:135], v10 offset:32768
    v_mov_b32_dpp v36, v44 row_newbcast:0 row_mask:0xf bank_mask:0xf
    v_perm_b32 v12, v36, v36, v4
    v_perm_b32 v13, v36, v36, v5
    v_perm_b32 v14, v36, v36, v6
    v_perm_b32 v15, v36, v36, v7
    s_waitcnt lgkmcnt(8)
    s_nop 0
    v_mfma_f32_16x16x32_bf16 v[24:27], v[12:15], a[228:231], 0
    v_mov_b32_dpp v36, v44 row_newbcast:1 row_mask:0xf bank_mask:0xf
    v_perm_b32 v16, v36, v36, v4
    s_waitcnt lgkmcnt(7)
    v_mfma_f32_16x16x32_bf16 v[28:31], v[12:15], a[232:235], 0
    v_perm_b32 v17, v36, v36, v5
    v_perm_b32 v18, v36, v36, v6
    v_perm_b32 v19, v36, v36, v7
    s_waitcnt lgkmcnt(6)
    v_mfma_f32_16x16x32_bf16 v[32:35], v[12:15], a[236:239], 0
    ds_read_b128 v[136:139], v10 offset:36864
    ds_read_b128 v[140:143], v3 offset:0
    ds_read_b128 v[144:147], v3 offset:4096
    s_waitcnt lgkmcnt(8)
    v_mfma_f32_16x16x32_bf16 v[24:27], v[16:19], a[240:243], v[24:27]
    v_mov_b32_dpp v36, v44 row_newbcast:2 row_mask:0xf bank_mask:0xf
    v_perm_b32 v12, v36, v36, v4
    s_waitcnt lgkmcnt(7)
    v_mfma_f32_16x16x32_bf16 v[28:31], v[16:19], a[244:247], v[28:31]
    v_perm_b32 v13, v36, v36, v5
    v_perm_b32 v14, v36, v36, v6
    v_perm_b32 v15, v36, v36, v7
    s_waitcnt lgkmcnt(6)
    v_mfma_f32_16x16x32_bf16 v[32:35], v[16:19], a[248:251], v[32:35]
    ds_read_b128 v[148:151], v3 offset:8192
    ds_read_b128 v[152:155], v3 offset:12288
    ds_read_b128 v[156:159], v3 offset:16384
    s_waitcnt lgkmcnt(8)
    v_mfma_f32_16x16x32_bf16 v[24:27], v[12:15], a[252:255], v[24:27]
    v_mov_b32_dpp v36, v44 row_newbcast:3 row_mask:0xf bank_mask:0xf
    v_perm_b32 v16, v36, v36, v4
    s_waitcnt lgkmcnt(7)
    v_mfma_f32_16x16x32_bf16 v[28:31], v[12:15], v[128:131], v[28:31]
    v_perm_b32 v17, v36, v36, v5
    v_perm_b32 v18, v36, v36, v6
    v_perm_b32 v19, v36, v36, v7
    s_waitcnt lgkmcnt(6)
    v_mfma_f32_16x16x32_bf16 v[32:35], v[12:15], v[132:135], v[32:35]
    ds_read_b128 v[160:163], v3 offset:20480
    ds_read_b128 v[164:167], v3 offset:24576
    ds_read_b128 v[168:171], v3 offset:28672
    s_waitcnt lgkmcnt(8)
    v_mfma_f32_16x16x32_bf16 v[24:27], v[16:19], v[136:139], v[24:27]
    v_mov_b32_dpp v36, v44 row_newbcast:4 row_mask:0xf bank_mask:0xf
    v_perm_b32 v12, v36, v36, v4
    s_waitcnt lgkmcnt(7)
    v_mfma_f32_16x16x32_bf16 v[28:31], v[16:19], v[140:143], v[28:31]
    v_perm_b32 v13, v36, v36, v5
    v_perm_b32 v14, v36, v36, v6
    v_perm_b32 v15, v36, v36, v7
    s_waitcnt lgkmcnt(6)
    v_mfma_f32_16x16x32_bf16 v[32:35], v[16:19], v[144:147], v[32:35]
    ds_read_b128 v[172:175], v3 offset:32768
    ds_read_b128 v[176:179], v3 offset:36864
    ds_read_b128 v[180:183], v3 offset:40960
    s_waitcnt lgkmcnt(8)
    v_mfma_f32_16x16x32_bf16 v[24:27], v[12:15], v[148:151], v[24:27]
    v_mov_b32_dpp v36, v44 row_newbcast:5 row_mask:0xf bank_mask:0xf
    v_perm_b32 v16, v36, v36, v4
    s_waitcnt lgkmcnt(7)
    v_mfma_f32_16x16x32_bf16 v[28:31], v[12:15], v[152:155], v[28:31]
    v_perm_b32 v17, v36, v36, v5
    v_perm_b32 v18, v36, v36, v6
    v_perm_b32 v19, v36, v36, v7
    s_waitcnt lgkmcnt(6)
    v_mfma_f32_16x16x32_bf16 v[32:35], v[12:15], v[156:159], v[32:35]
    ds_read_b128 v[184:187], v3 offset:45056
    ds_read_b128 v[188:191], v3 offset:49152
    ds_read_b128 v[192:195], v3 offset:53248
    s_waitcnt lgkmcnt(8)
    v_mfma_f32_16x16x32_bf16 v[24:27], v[16:19], v[160:163], v[24:27]
    v_mov_b32_dpp v36, v44 row_newbcast:6 row_mask:0xf bank_mask:0xf
    v_perm_b32 v12, v36, v36, v4
    s_waitcnt lgkmcnt(7)
    v_mfma_f32_16x16x32_bf16 v[28:31], v[16:19], v[164:167], v[28:31]
    v_perm_b32 v13, v36, v36, v5
    v_perm_b32 v14, v36, v36, v6
    v_perm_b32 v15, v36, v36, v7
    s_waitcnt lgkmcnt(6)
    v_mfma_f32_16x16x32_bf16 v[32:35], v[16:19], v[168:171], v[32:35]
    ds_read_b128 v[196:199], v3 offset:57344
    ds_read_b128 v[200:203], v3 offset:61440
    ds_read_b128 v[208:211], v10 offset:40960
    s_waitcnt lgkmcnt(8)
    v_mfma_f32_16x16x32_bf16 v[24:27], v[12:15], v[172:175], v[24:27]
    v_mov_b32_dpp v36, v44 row_newbcast:7 row_mask:0xf bank_mask:0xf
    v_perm_b32 v16, v36, v36, v4
    s_waitcnt lgkmcnt(7)
    v_mfma_f32_16x16x32_bf16 v[28:31], v[12:15], v[176:179], v[28:31]
    v_perm_b32 v17, v36, v36, v5
    v_perm_b32 v18, v36, v36, v6
    v_perm_b32 v19, v36, v36, v7
    s_waitcnt lgkmcnt(6)
    v_mfma_f32_16x16x32_bf16 v[32:35], v[12:15], v[180:183], v[32:35]
    ds_read_b128 v[212:215], v10 offset:45056
    ds_read_b128 v[216:219], v10 offset:49152
    ds_read_b128 v[220:223], v10 offset:53248
    s_waitcnt lgkmcnt(8)
    v_mfma_f32_16x16x32_bf16 v[24:27], v[16:19], v[184:187], v[24:27]
    v_mov_b32_dpp v36, v45 row_newbcast:0 row_mask:0xf bank_mask:0xf
    v_perm_b32 v12, v36, v36, v4
    s_waitcnt lgkmcnt(7)
    v_mfma_f32_16x16x32_bf16 v[28:31], v[16:19], v[188:191], v[28:31]
    v_perm_b32 v13, v36, v36, v5
    v_perm_b32 v14, v36, v36, v6
    v_perm_b32 v15, v36, v36, v7
    s_waitcnt lgkmcnt(6)
    v_mfma_f32_16x16x32_bf16 v[32:35], v[16:19], v[192:195], v[32:35]
    ds_read_b128 v[224:227], v10 offset:57344
    ds_read_b128 v[228:231], v10 offset:61440
    ds_read_b128 v[232:235], v11 offset:0
    s_waitcnt lgkmcnt(8)
    v_mfma_f32_16x16x32_bf16 v[24:27], v[12:15], v[196:199], v[24:27]
    v_mov_b32_dpp v36, v45 row_newbcast:1 row_mask:0xf bank_mask:0xf
    v_perm_b32 v16, v36, v36, v4
    s_waitcnt lgkmcnt(7)
    v_mfma_f32_16x16x32_bf16 v[28:31], v[12:15], v[200:203], v[28:31]
    v_perm_b32 v17, v36, v36, v5
    v_perm_b32 v18, v36, v36, v6
    v_perm_b32 v19, v36, v36, v7
    v_mfma_f32_16x16x32_bf16 v[32:35], v[12:15], v[64:67], v[32:35]
    ds_read_b128 v[236:239], v11 offset:4096
    ds_read_b128 v[240:243], v11 offset:8192
    ds_read_b128 v[244:247], v11 offset:12288
    s_barrier
    s_cmp_lg_u32 s7, 0
    s_cbranch_scc1 Ls_25
    v_lshrrev_b32 v21, 7, v0
    v_mul_u32_u24 v21, 1280, v21
    v_and_b32 v20, 0x70, v0
    v_or_b32 v20, v20, v21
    v_bfe_u32 v21, v0, 8, 1
    v_lshlrev_b32 v21, 5, v21
    v_xor_b32 v20, v20, v21
    v_xor_b32 v21, 64, v20
    s_lshr_b32 s64, s4, 1
    s_lshl_b32 s64, s64, 7
    s_mul_i32 s65, s75, 163840
    s_add_u32 s64, s64, s65
    s_lshl_b32 m0, s4, 14
    s_nop 0
    buffer_load_dwordx4 v20, s[24:27], s64 offen nt lds
    s_add_u32 m0, m0, 1024
    s_add_u32 s64, s64, 10240
    buffer_load_dwordx4 v21, s[24:27], s64 offen nt lds
    s_add_u32 m0, m0, 1024
    s_add_u32 s64, s64, 10240
    buffer_load_dwordx4 v20, s[24:27], s64 offen nt lds
    s_add_u32 m0, m0, 1024
    s_add_u32 s64, s64, 10240
    buffer_load_dwordx4 v21, s[24:27], s64 offen nt lds
    s_add_u32 m0, m0, 1024
    s_add_u32 s64, s64, 10240
    buffer_load_dwordx4 v20, s[24:27], s64 offen nt lds
    s_add_u32 m0, m0, 1024
    s_add_u32 s64, s64, 10240
    buffer_load_dwordx4 v21, s[24:27], s64 offen nt lds
    s_add_u32 m0, m0, 1024
    s_add_u32 s64, s64, 10240
    buffer_load_dwordx4 v20, s[24:27], s64 offen nt lds
    s_add_u32 m0, m0, 1024
    s_add_u32 s64, s64, 10240
    buffer_load_dwordx4 v21, s[24:27], s64 offen nt lds
    s_add_u32 m0, m0, 1024
    s_add_u32 s64, s64, 10240
    buffer_load_dwordx4 v20, s[24:27], s64 offen nt lds
    s_add_u32 m0, m0, 1024
    s_add_u32 s64, s64, 10240
    buffer_load_dwordx4 v21, s[24:27], s64 offen nt lds
    s_add_u32 m0, m0, 1024
    s_add_u32 s64, s64, 10240
    buffer_load_dwordx4 v20, s[24:27], s64 offen nt lds
    s_add_u32 m0, m0, 1024
    s_add_u32 s64, s64, 10240
    buffer_load_dwordx4 v21, s[24:27], s64 offen nt lds
    s_add_u32 m0, m0, 1024
    s_add_u32 s64, s64, 10240
    buffer_load_dwordx4 v20, s[24:27], s64 offen nt lds
    s_add_u32 m0, m0, 1024
    s_add_u32 s64, s64, 10240
    buffer_load_dwordx4 v21, s[24:27], s64 offen nt lds
    s_add_u32 m0, m0, 1024
    s_add_u32 s64, s64, 10240
    buffer_load_dwordx4 v20, s[24:27], s64 offen nt lds
    s_add_u32 m0, m0, 1024
    s_add_u32 s64, s64, 10240
    buffer_load_dwordx4 v21, s[24:27], s64 offen nt lds
    s_branch Ls_27
Ls_25:
Ls_27:
    s_waitcnt lgkmcnt(9)
    v_mfma_f32_16x16x32_bf16 v[24:27], v[16:19], v[208:211], v[24:27]
    v_mov_b32_dpp v36, v45 row_newbcast:2 row_mask:0xf bank_mask:0xf
    v_perm_b32 v12, v36, v36, v4
    s_waitcnt lgkmcnt(8)
    v_mfma_f32_16x16x32_bf16 v[28:31], v[16:19], v[212:215], v[28:31]
    v_perm_b32 v13, v36, v36, v5
    v_perm_b32 v14, v36, v36, v6
    v_perm_b32 v15, v36, v36, v7
    s_waitcnt lgkmcnt(7)
    v_mfma_f32_16x16x32_bf16 v[32:35], v[16:19], v[216:219], v[32:35]
    ds_read_b128 v[248:251], v11 offset:16384
    ds_read_b128 v[252:255], v11 offset:20480
    s_waitcnt lgkmcnt(8)
    v_mfma_f32_16x16x32_bf16 v[24:27], v[12:15], v[220:223], v[24:27]
    v_mov_b32_dpp v36, v45 row_newbcast:3 row_mask:0xf bank_mask:0xf
    v_perm_b32 v16, v36, v36, v4
    s_waitcnt lgkmcnt(7)
    v_mfma_f32_16x16x32_bf16 v[28:31], v[12:15], v[224:227], v[28:31]
    v_perm_b32 v17, v36, v36, v5
    v_perm_b32 v18, v36, v36, v6
    v_perm_b32 v19, v36, v36, v7
    s_waitcnt lgkmcnt(6)
    v_mfma_f32_16x16x32_bf16 v[32:35], v[12:15], v[228:231], v[32:35]
    s_waitcnt lgkmcnt(5)
    v_mfma_f32_16x16x32_bf16 v[24:27], v[16:19], v[232:235], v[24:27]
    v_mov_b32_dpp v36, v45 row_newbcast:4 row_mask:0xf bank_mask:0xf
    v_perm_b32 v12, v36, v36, v4
    s_waitcnt lgkmcnt(4)
    v_mfma_f32_16x16x32_bf16 v[28:31], v[16:19], v[236:239], v[28:31]
    v_perm_b32 v13, v36, v36, v5
    v_perm_b32 v14, v36, v36, v6
    v_perm_b32 v15, v36, v36, v7
    s_waitcnt lgkmcnt(3)
    v_mfma_f32_16x16x32_bf16 v[32:35], v[16:19], v[240:243], v[32:35]
    s_waitcnt lgkmcnt(2)
    v_mfma_f32_16x16x32_bf16 v[24:27], v[12:15], v[244:247], v[24:27]
    v_mov_b32_dpp v36, v47 row_newbcast:3 row_mask:0xf bank_mask:0xf
    v_perm_b32 v16, v36, v36, v4
    s_waitcnt lgkmcnt(1)
    v_mfma_f32_16x16x32_bf16 v[28:31], v[12:15], v[248:251], v[28:31]
    v_perm_b32 v17, v36, v36, v5
    v_perm_b32 v18, v36, v36, v6
    v_perm_b32 v19, v36, v36, v7
    s_waitcnt lgkmcnt(0)
    v_mfma_f32_16x16x32_bf16 v[32:35], v[12:15], v[252:255], v[32:35]
    v_mfma_f32_16x16x32_bf16 v[24:27], v[16:19], v[104:107], v[24:27]
    v_mov_b32_dpp v36, v47 row_newbcast:4 row_mask:0xf bank_mask:0xf
    v_perm_b32 v12, v36, v36, v4
    v_mfma_f32_16x16x32_bf16 v[28:31], v[16:19], v[108:111], v[28:31]
    v_perm_b32 v13, v36, v36, v5
    v_perm_b32 v14, v36, v36, v6
    v_perm_b32 v15, v36, v36, v7
    v_mfma_f32_16x16x32_bf16 v[32:35], v[16:19], v[112:115], v[32:35]
    s_nop 0
    v_mfma_f32_16x16x32_bf16 v[24:27], v[12:15], v[116:119], v[24:27]
    v_mov_b32_dpp v36, v47 row_newbcast:5 row_mask:0xf bank_mask:0xf
    v_perm_b32 v16, v36, v36, v4
    v_mfma_f32_16x16x32_bf16 v[28:31], v[12:15], v[120:123], v[28:31]
    v_perm_b32 v17, v36, v36, v5
    v_perm_b32 v18, v36, v36, v6
    v_perm_b32 v19, v36, v36, v7
    v_mfma_f32_16x16x32_bf16 v[32:35], v[12:15], v[124:127], v[32:35]
    s_nop 0
    v_mfma_f32_16x16x32_bf16 v[24:27], v[16:19], v[68:71], v[24:27]
    v_mov_b32_dpp v36, v47 row_newbcast:6 row_mask:0xf bank_mask:0xf
    v_perm_b32 v12, v36, v36, v4
    v_mfma_f32_16x16x32_bf16 v[28:31], v[16:19], v[72:75], v[28:31]
    v_perm_b32 v13, v36, v36, v5
    v_perm_b32 v14, v36, v36, v6
    v_perm_b32 v15, v36, v36, v7
    v_mfma_f32_16x16x32_bf16 v[32:35], v[16:19], v[76:79], v[32:35]
    s_nop 0
    v_mfma_f32_16x16x32_bf16 v[24:27], v[12:15], v[80:83], v[24:27]
    v_mov_b32_dpp v36, v47 row_newbcast:7 row_mask:0xf bank_mask:0xf
    v_perm_b32 v16, v36, v36, v4
    v_mfma_f32_16x16x32_bf16 v[28:31], v[12:15], v[84:87], v[28:31]
    v_perm_b32 v17, v36, v36, v5
    v_perm_b32 v18, v36, v36, v6
    v_perm_b32 v19, v36, v36, v7
    v_mfma_f32_16x16x32_bf16 v[32:35], v[12:15], v[88:91], v[32:35]
    s_nop 0
    v_mfma_f32_16x16x32_bf16 v[24:27], v[16:19], v[92:95], v[24:27]
    v_mov_b32_dpp v36, v45 row_newbcast:5 row_mask:0xf bank_mask:0xf
    v_perm_b32 v12, v36, v36, v4
    v_mfma_f32_16x16x32_bf16 v[28:31], v[16:19], v[96:99], v[28:31]
    v_perm_b32 v13, v36, v36, v5
    v_perm_b32 v14, v36, v36, v6
    v_perm_b32 v15, v36, v36, v7
    v_mfma_f32_16x16x32_bf16 v[32:35], v[16:19], v[100:103], v[32:35]
    s_waitcnt vmcnt(8)
    v_mfma_f32_16x16x32_bf16 v[24:27], v[12:15], a[0:3], v[24:27]
    v_mov_b32_dpp v36, v46 row_newbcast:4 row_mask:0xf bank_mask:0xf
    v_perm_b32 v16, v36, v36, v4
    s_waitcnt vmcnt(7)
    v_mfma_f32_16x16x32_bf16 v[28:31], v[12:15], a[4:7], v[28:31]
    v_perm_b32 v17, v36, v36, v5
    v_perm_b32 v18, v36, v36, v6
    v_perm_b32 v19, v36, v36, v7
    s_waitcnt vmcnt(6)
    v_mfma_f32_16x16x32_bf16 v[32:35], v[12:15], a[8:11], v[32:35]
    s_add_u32 s63, s57, 49152
    buffer_load_dwordx4 a[36:39], v2, s[12:15], s63 offen offset:1920 nt
    buffer_load_dwordx4 a[40:43], v2, s[12:15], s63 offen offset:2048 nt
    buffer_load_dwordx4 a[44:47], v2, s[12:15], s63 offen offset:2176 nt
    s_waitcnt vmcnt(8)
    v_mfma_f32_16x16x32_bf16 v[24:27], v[16:19], a[12:15], v[24:27]
    v_mov_b32_dpp v36, v45 row_newbcast:6 row_mask:0xf bank_mask:0xf
    v_perm_b32 v12, v36, v36, v4
    s_waitcnt vmcnt(7)
    v_mfma_f32_16x16x32_bf16 v[28:31], v[16:19], a[16:19], v[28:31]
    v_perm_b32 v13, v36, v36, v5
    v_perm_b32 v14, v36, v36, v6
    v_perm_b32 v15, v36, v36, v7
    s_waitcnt vmcnt(6)
    v_mfma_f32_16x16x32_bf16 v[32:35], v[16:19], a[20:23], v[32:35]
    s_add_u32 s63, s57, 24576
    buffer_load_dwordx4 a[48:51], v2, s[12:15], s63 offen offset:2688 nt
    buffer_load_dwordx4 a[52:55], v2, s[12:15], s63 offen offset:2816 nt
    buffer_load_dwordx4 a[56:59], v2, s[12:15], s63 offen offset:2944 nt
    s_waitcnt vmcnt(8)
    v_mfma_f32_16x16x32_bf16 v[24:27], v[12:15], a[24:27], v[24:27]
    v_mov_b32_dpp v36, v46 row_newbcast:5 row_mask:0xf bank_mask:0xf
    v_perm_b32 v16, v36, v36, v4
    s_waitcnt vmcnt(7)
    v_mfma_f32_16x16x32_bf16 v[28:31], v[12:15], a[28:31], v[28:31]
    v_perm_b32 v17, v36, v36, v5
    v_perm_b32 v18, v36, v36, v6
    v_perm_b32 v19, v36, v36, v7
    s_waitcnt vmcnt(6)
    v_mfma_f32_16x16x32_bf16 v[32:35], v[12:15], a[32:35], v[32:35]
    s_add_u32 s63, s57, 49152
    buffer_load_dwordx4 a[60:63], v2, s[12:15], s63 offen offset:2304 nt
    buffer_load_dwordx4 a[64:67], v2, s[12:15], s63 offen offset:2432 nt
    buffer_load_dwordx4 a[68:71], v2, s[12:15], s63 offen offset:2560 nt
    s_waitcnt vmcnt(8)
    v_mfma_f32_16x16x32_bf16 v[24:27], v[16:19], a[36:39], v[24:27]
    v_mov_b32_dpp v36, v45 row_newbcast:7 row_mask:0xf bank_mask:0xf
    v_perm_b32 v12, v36, v36, v4
    s_waitcnt vmcnt(7)
    v_mfma_f32_16x16x32_bf16 v[28:31], v[16:19], a[40:43], v[28:31]
    v_perm_b32 v13, v36, v36, v5
    v_perm_b32 v14, v36, v36, v6
    v_perm_b32 v15, v36, v36, v7
    s_waitcnt vmcnt(6)
    v_mfma_f32_16x16x32_bf16 v[32:35], v[16:19], a[44:47], v[32:35]
    s_add_u32 s63, s57, 49152
    buffer_load_dwordx4 a[72:75], v2, s[12:15], s63 offen offset:0 nt
    buffer_load_dwordx4 a[76:79], v2, s[12:15], s63 offen offset:128 nt
    buffer_load_dwordx4 a[80:83], v2, s[12:15], s63 offen offset:256 nt
    s_waitcnt vmcnt(8)
    v_mfma_f32_16x16x32_bf16 v[24:27], v[12:15], a[48:51], v[24:27]
    v_mov_b32_dpp v36, v46 row_newbcast:6 row_mask:0xf bank_mask:0xf
    v_perm_b32 v16, v36, v36, v4
    s_waitcnt vmcnt(7)
    v_mfma_f32_16x16x32_bf16 v[28:31], v[12:15], a[52:55], v[28:31]
    v_perm_b32 v17, v36, v36, v5
    v_perm_b32 v18, v36, v36, v6
    v_perm_b32 v19, v36, v36, v7
    s_waitcnt vmcnt(6)
    v_mfma_f32_16x16x32_bf16 v[32:35], v[12:15], a[56:59], v[32:35]
    s_add_u32 s63, s57, 49152
    buffer_load_dwordx4 a[84:87], v2, s[12:15], s63 offen offset:2688 nt
    buffer_load_dwordx4 a[88:91], v2, s[12:15], s63 offen offset:2816 nt
    buffer_load_dwordx4 a[92:95], v2, s[12:15], s63 offen offset:2944 nt
    s_waitcnt vmcnt(8)
    v_mfma_f32_16x16x32_bf16 v[24:27], v[16:19], a[60:63], v[24:27]
    v_mov_b32_dpp v36, v46 row_newbcast:0 row_mask:0xf bank_mask:0xf
    v_perm_b32 v12, v36, v36, v4
    s_waitcnt vmcnt(7)
    v_mfma_f32_16x16x32_bf16 v[28:31], v[16:19], a[64:67], v[28:31]
    v_perm_b32 v13, v36, v36, v5
    v_perm_b32 v14, v36, v36, v6
    v_perm_b32 v15, v36, v36, v7
    s_waitcnt vmcnt(6)
    v_mfma_f32_16x16x32_bf16 v[32:35], v[16:19], a[68:71], v[32:35]
    s_add_u32 s63, s57, 49152
    buffer_load_dwordx4 a[96:99], v2, s[12:15], s63 offen offset:384 nt
    buffer_load_dwordx4 a[100:103], v2, s[12:15], s63 offen offset:512 nt
    buffer_load_dwordx4 a[104:107], v2, s[12:15], s63 offen offset:640 nt
    s_waitcnt vmcnt(8)
    v_mfma_f32_16x16x32_bf16 v[24:27], v[12:15], a[72:75], v[24:27]
    v_mov_b32_dpp v36, v46 row_newbcast:7 row_mask:0xf bank_mask:0xf
    v_perm_b32 v16, v36, v36, v4
    s_waitcnt vmcnt(7)
    v_mfma_f32_16x16x32_bf16 v[28:31], v[12:15], a[76:79], v[28:31]
    v_perm_b32 v17, v36, v36, v5
    v_perm_b32 v18, v36, v36, v6
    v_perm_b32 v19, v36, v36, v7
    s_waitcnt vmcnt(6)
    v_mfma_f32_16x16x32_bf16 v[32:35], v[12:15], a[80:83], v[32:35]
    s_add_u32 s63, s57, 73728
    buffer_load_dwordx4 a[108:111], v2, s[12:15], s63 offen offset:0 nt
    buffer_load_dwordx4 a[112:115], v2, s[12:15], s63 offen offset:128 nt
    buffer_load_dwordx4 a[116:119], v2, s[12:15], s63 offen offset:256 nt
    s_waitcnt vmcnt(8)
    v_mfma_f32_16x16x32_bf16 v[24:27], v[16:19], a[84:87], v[24:27]
    v_mov_b32_dpp v36, v46 row_newbcast:1 row_mask:0xf bank_mask:0xf
    v_perm_b32 v12, v36, v36, v4
    s_waitcnt vmcnt(7)
    v_mfma_f32_16x16x32_bf16 v[28:31], v[16:19], a[88:91], v[28:31]
    v_perm_b32 v13, v36, v36, v5
    v_perm_b32 v14, v36, v36, v6
    v_perm_b32 v15, v36, v36, v7
    s_waitcnt vmcnt(6)
    v_mfma_f32_16x16x32_bf16 v[32:35], v[16:19], a[92:95], v[32:35]
    s_add_u32 s63, s57, 49152
    buffer_load_dwordx4 a[120:123], v2, s[12:15], s63 offen offset:768 nt
    buffer_load_dwordx4 a[124:127], v2, s[12:15], s63 offen offset:896 nt
    buffer_load_dwordx4 a[128:131], v2, s[12:15], s63 offen offset:1024 nt
    s_waitcnt vmcnt(8)
    v_mfma_f32_16x16x32_bf16 v[24:27], v[12:15], a[96:99], v[24:27]
    v_mov_b32_dpp v36, v47 row_newbcast:0 row_mask:0xf bank_mask:0xf
    v_perm_b32 v16, v36, v36, v4
    s_waitcnt vmcnt(7)
    v_mfma_f32_16x16x32_bf16 v[28:31], v[12:15], a[100:103], v[28:31]
    v_perm_b32 v17, v36, v36, v5
    v_perm_b32 v18, v36, v36, v6
    v_perm_b32 v19, v36, v36, v7
    s_waitcnt vmcnt(6)
    v_mfma_f32_16x16x32_bf16 v[32:35], v[12:15], a[104:107], v[32:35]
    s_add_u32 s63, s57, 73728
    buffer_load_dwordx4 a[132:135], v2, s[12:15], s63 offen offset:384 nt
    buffer_load_dwordx4 a[136:139], v2, s[12:15], s63 offen offset:512 nt
    buffer_load_dwordx4 a[140:143], v2, s[12:15], s63 offen offset:640 nt
    s_waitcnt vmcnt(8)
    v_mfma_f32_16x16x32_bf16 v[24:27], v[16:19], a[108:111], v[24:27]
    v_mov_b32_dpp v36, v46 row_newbcast:2 row_mask:0xf bank_mask:0xf
    v_perm_b32 v12, v36, v36, v4
    s_waitcnt vmcnt(7)
    v_mfma_f32_16x16x32_bf16 v[28:31], v[16:19], a[112:115], v[28:31]
    v_perm_b32 v13, v36, v36, v5
    v_perm_b32 v14, v36, v36, v6
    v_perm_b32 v15, v36, v36, v7
    s_waitcnt vmcnt(6)
    v_mfma_f32_16x16x32_bf16 v[32:35], v[16:19], a[116:119], v[32:35]
    s_add_u32 s63, s57, 49152
    buffer_load_dwordx4 a[144:147], v2, s[12:15], s63 offen offset:1152 nt
    buffer_load_dwordx4 a[148:151], v2, s[12:15], s63 offen offset:1280 nt
    buffer_load_dwordx4 a[152:155], v2, s[12:15], s63 offen offset:1408 nt
    s_waitcnt vmcnt(8)
    v_mfma_f32_16x16x32_bf16 v[24:27], v[12:15], a[120:123], v[24:27]
    v_mov_b32_dpp v36, v47 row_newbcast:1 row_mask:0xf bank_mask:0xf
    v_perm_b32 v16, v36, v36, v4
    s_waitcnt vmcnt(7)
    v_mfma_f32_16x16x32_bf16 v[28:31], v[12:15], a[124:127], v[28:31]
    v_perm_b32 v17, v36, v36, v5
    v_perm_b32 v18, v36, v36, v6
    v_perm_b32 v19, v36, v36, v7
    s_waitcnt vmcnt(6)
    v_mfma_f32_16x16x32_bf16 v[32:35], v[12:15], a[128:131], v[32:35]
    s_add_u32 s63, s57, 73728
    buffer_load_dwordx4 a[156:159], v2, s[12:15], s63 offen offset:768 nt
    buffer_load_dwordx4 a[160:163], v2, s[12:15], s63 offen offset:896 nt
    buffer_load_dwordx4 a[164:167], v2, s[12:15], s63 offen offset:1024 nt
    s_waitcnt vmcnt(8)
    v_mfma_f32_16x16x32_bf16 v[24:27], v[16:19], a[132:135], v[24:27]
    v_mov_b32_dpp v36, v46 row_newbcast:3 row_mask:0xf bank_mask:0xf
    v_perm_b32 v12, v36, v36, v4
    s_waitcnt vmcnt(7)
    v_mfma_f32_16x16x32_bf16 v[28:31], v[16:19], a[136:139], v[28:31]
    v_perm_b32 v13, v36, v36, v5
    v_perm_b32 v14, v36, v36, v6
    v_perm_b32 v15, v36, v36, v7
    s_waitcnt vmcnt(6)
    v_mfma_f32_16x16x32_bf16 v[32:35], v[16:19], a[140:143], v[32:35]
    s_waitcnt vmcnt(5)
    v_mfma_f32_16x16x32_bf16 v[24:27], v[12:15], a[144:147], v[24:27]
    v_mov_b32_dpp v36, v47 row_newbcast:2 row_mask:0xf bank_mask:0xf
    v_perm_b32 v16, v36, v36, v4
    s_waitcnt vmcnt(4)
    v_mfma_f32_16x16x32_bf16 v[28:31], v[12:15], a[148:151], v[28:31]
    v_perm_b32 v17, v36, v36, v5
    v_perm_b32 v18, v36, v36, v6
    v_perm_b32 v19, v36, v36, v7
    s_waitcnt vmcnt(3)
    v_mfma_f32_16x16x32_bf16 v[32:35], v[12:15], a[152:155], v[32:35]
    s_waitcnt vmcnt(2)
    v_mfma_f32_16x16x32_bf16 v[24:27], v[16:19], a[156:159], v[24:27]
    s_waitcnt vmcnt(1)
    v_mfma_f32_16x16x32_bf16 v[28:31], v[16:19], a[160:163], v[28:31]
    s_waitcnt vmcnt(0)
    v_mfma_f32_16x16x32_bf16 v[32:35], v[16:19], a[164:167], v[32:35]
    s_nop 7
    s_call_b64 s[70:71], Lepi
    s_mov_b32 s81, s4
    s_cmp_eq_u32 s7, 1
    s_cbranch_scc1 LQ_28
    s_cmp_lg_u32 s7, 0
    s_cbranch_scc1 Ls_30
    s_call_b64 s[70:71], LpollA
Ls_30:
    buffer_load_dwordx4 v[160:163], v2, s[20:23], s58 offen offset:0 nt
    buffer_load_dwordx4 v[164:167], v2, s[20:23], s58 offen offset:128 nt
    buffer_load_dwordx4 v[168:171], v2, s[20:23], s58 offen offset:256 nt
    buffer_load_dwordx4 v[172:175], v2, s[20:23], s58 offen offset:384 nt
    s_cmp_lg_u32 s7, 0
    s_cbranch_scc1 Ls_31
    s_call_b64 s[70:71], Loproj
    s_barrier
Ls_31:
    buffer_load_dwordx4 v[176:179], v2, s[20:23], s58 offen offset:512 nt
    s_waitcnt vmcnt(7)
    buffer_load_dwordx4 v[180:183], v2, s[20:23], s58 offen offset:640 nt
    s_waitcnt vmcnt(7)
    buffer_load_dwordx4 v[184:187], v2, s[20:23], s58 offen offset:768 nt
    s_waitcnt vmcnt(7)
    buffer_load_dwordx4 v[188:191], v2, s[20:23], s58 offen offset:896 nt
    s_waitcnt vmcnt(7)
    buffer_load_dwordx4 v[192:195], v2, s[20:23], s58 offen offset:1024 nt
    s_waitcnt vmcnt(7)
    buffer_load_dwordx4 v[196:199], v2, s[20:23], s58 offen offset:1152 nt
    s_waitcnt vmcnt(7)
    s_branch LJ_29
LQ_28:
    v_lshrrev_b32 v19, 9, v0
    v_mul_u32_u24 v19, 12320, v19
    v_and_b32 v18, 0x1f0, v0
    v_xor_b32 v18, v18, v19
    v_xor_b32 v19, 64, v18
    s_mul_i32 s64, s4, 393216
    s_lshl_b32 m0, s4, 14
    s_nop 0
    buffer_load_dwordx4 v18, s[28:31], s64 offen nt lds
    s_waitcnt vmcnt(7)
    s_add_u32 m0, m0, 1024
    s_add_u32 s64, s64, 24576
    buffer_load_dwordx4 v19, s[28:31], s64 offen nt lds
    s_waitcnt vmcnt(7)
    s_add_u32 m0, m0, 1024
    s_add_u32 s64, s64, 24576
    buffer_load_dwordx4 v18, s[28:31], s64 offen nt lds
    s_waitcnt vmcnt(7)
    s_add_u32 m0, m0, 1024
    s_add_u32 s64, s64, 24576
    buffer_load_dwordx4 v19, s[28:31], s64 offen nt lds
    s_waitcnt vmcnt(7)
    s_add_u32 m0, m0, 1024
    s_add_u32 s64, s64, 24576
    v_xor_b32 v18, 128, v18
    v_xor_b32 v19, 128, v19
    buffer_load_dwordx4 v18, s[28:31], s64 offen nt lds
    s_waitcnt vmcnt(7)
    s_add_u32 m0, m0, 1024
    s_add_u32 s64, s64, 24576
    buffer_load_dwordx4 v19, s[28:31], s64 offen nt lds
    s_waitcnt vmcnt(7)
    s_add_u32 m0, m0, 1024
    s_add_u32 s64, s64, 24576
    buffer_load_dwordx4 v18, s[28:31], s64 offen nt lds
    s_waitcnt vmcnt(7)
    s_add_u32 m0, m0, 1024
    s_add_u32 s64, s64, 24576
    buffer_load_dwordx4 v19, s[28:31], s64 offen nt lds
    s_waitcnt vmcnt(7)
    s_add_u32 m0, m0, 1024
    s_add_u32 s64, s64, 24576
    v_xor_b32 v18, 128, v18
    v_xor_b32 v19, 128, v19
    buffer_load_dwordx4 v18, s[28:31], s64 offen nt lds
    s_waitcnt vmcnt(7)
    s_add_u32 m0, m0, 1024
    s_add_u32 s64, s64, 24576
    buffer_load_dwordx4 v19, s[28:31], s64 offen nt lds
    s_waitcnt vmcnt(7)
    s_add_u32 m0, m0, 1024
    s_add_u32 s64, s64, 24576
    buffer_load_dwordx4 v18, s[28:31], s64 offen nt lds
    s_waitcnt vmcnt(7)
    s_add_u32 m0, m0, 1024
    s_add_u32 s64, s64, 24576
    buffer_load_dwordx4 v19, s[28:31], s64 offen nt lds
    s_waitcnt vmcnt(7)
    s_add_u32 m0, m0, 1024
    s_add_u32 s64, s64, 24576
    v_xor_b32 v18, 128, v18
    v_xor_b32 v19, 128, v19
    buffer_load_dwordx4 v18, s[28:31], s64 offen nt lds
    s_waitcnt vmcnt(7)
    s_add_u32 m0, m0, 1024
    s_add_u32 s64, s64, 24576
    buffer_load_dwordx4 v19, s[28:31], s64 offen nt lds
    s_waitcnt vmcnt(7)
    s_add_u32 m0, m0, 1024
    s_add_u32 s64, s64, 24576
    buffer_load_dwordx4 v18, s[28:31], s64 offen nt lds
    s_waitcnt vmcnt(7)
    s_add_u32 m0, m0, 1024
    s_add_u32 s64, s64, 24576
    buffer_load_dwordx4 v19, s[28:31], s64 offen nt lds
    s_waitcnt vmcnt(7)
    buffer_load_dwordx4 v[160:163], v2, s[20:23], s58 offen offset:0 nt
    s_waitcnt vmcnt(7)
    buffer_load_dwordx4 v[164:167], v2, s[20:23], s58 offen offset:128 nt
    s_waitcnt vmcnt(7)
    buffer_load_dwordx4 v[168:171], v2, s[20:23], s58 offen offset:256 nt
    s_waitcnt vmcnt(7)
    buffer_load_dwordx4 v[172:175], v2, s[20:23], s58 offen offset:384 nt
    s_waitcnt vmcnt(7)
    buffer_load_dwordx4 v[176:179], v2, s[20:23], s58 offen offset:512 nt
    s_waitcnt vmcnt(7)
    buffer_load_dwordx4 v[180:183], v2, s[20:23], s58 offen offset:640 nt
    s_waitcnt vmcnt(7)
    buffer_load_dwordx4 v[184:187], v2, s[20:23], s58 offen offset:768 nt
    s_waitcnt vmcnt(7)
    buffer_load_dwordx4 v[188:191], v2, s[20:23], s58 offen offset:896 nt
    s_waitcnt vmcnt(7)
    buffer_load_dwordx4 v[192:195], v2, s[20:23], s58 offen offset:1024 nt
    s_waitcnt vmcnt(7)
    buffer_load_dwordx4 v[196:199], v2, s[20:23], s58 offen offset:1152 nt
    s_waitcnt vmcnt(7)
    s_call_b64 s[70:71], LpollB
    s_call_b64 s[72:73], Lqproj
    s_barrier
LJ_29:
    buffer_load_dwordx4 a[192:195], v1, s[16:19], s58 offen offset:0 nt
    s_waitcnt vmcnt(7)
    buffer_load_dwordx4 a[196:199], v1, s[16:19], s58 offen offset:128 nt
    s_waitcnt vmcnt(7)
    buffer_load_dwordx4 a[200:203], v1, s[16:19], s58 offen offset:256 nt
    s_waitcnt vmcnt(7)
    buffer_load_dwordx4 a[204:207], v1, s[16:19], s58 offen offset:3072 nt
    s_waitcnt vmcnt(7)
    buffer_load_dwordx4 a[208:211], v1, s[16:19], s58 offen offset:3200 nt
    s_waitcnt vmcnt(7)
    buffer_load_dwordx4 a[212:215], v1, s[16:19], s58 offen offset:3328 nt
    s_waitcnt vmcnt(7)
    s_add_u32 s60, s58, 6144
    buffer_load_dwordx4 a[216:219], v1, s[16:19], s60 offen offset:0 nt
    s_waitcnt vmcnt(7)
    s_add_u32 s60, s58, 6144
    buffer_load_dwordx4 a[220:223], v1, s[16:19], s60 offen offset:128 nt
    s_waitcnt vmcnt(7)
    s_add_u32 s60, s58, 6144
    buffer_load_dwordx4 a[224:227], v1, s[16:19], s60 offen offset:256 nt
    s_waitcnt vmcnt(7)
    s_add_u32 s60, s58, 6144
    buffer_load_dwordx4 a[228:231], v1, s[16:19], s60 offen offset:3072 nt
    s_waitcnt vmcnt(7)
    s_add_u32 s60, s58, 6144
    buffer_load_dwordx4 a[232:235], v1, s[16:19], s60 offen offset:3200 nt
    s_waitcnt vmcnt(7)
    s_add_u32 s60, s58, 6144
    buffer_load_dwordx4 a[236:239], v1, s[16:19], s60 offen offset:3328 nt
    s_waitcnt vmcnt(7)
    s_add_u32 s60, s58, 12288
    buffer_load_dwordx4 a[240:243], v1, s[16:19], s60 offen offset:0 nt
    s_waitcnt vmcnt(7)
    s_add_u32 s60, s58, 12288
    buffer_load_dwordx4 a[244:247], v1, s[16:19], s60 offen offset:128 nt
    s_waitcnt vmcnt(7)
    s_add_u32 s60, s58, 12288
    buffer_load_dwordx4 a[248:251], v1, s[16:19], s60 offen offset:256 nt
    s_waitcnt vmcnt(7)
    s_add_u32 s60, s58, 12288
    buffer_load_dwordx4 a[252:255], v1, s[16:19], s60 offen offset:3072 nt
    s_waitcnt vmcnt(7)
    s_add_u32 s60, s58, 12288
    buffer_load_dwordx4 v[128:131], v1, s[16:19], s60 offen offset:3200 nt
    s_waitcnt vmcnt(7)
    s_add_u32 s60, s58, 12288
    buffer_load_dwordx4 v[132:135], v1, s[16:19], s60 offen offset:3328 nt
    s_waitcnt vmcnt(7)
    s_add_u32 s60, s58, 18432
    buffer_load_dwordx4 v[136:139], v1, s[16:19], s60 offen offset:0 nt
    s_waitcnt vmcnt(7)
    s_add_u32 s60, s58, 18432
    buffer_load_dwordx4 v[140:143], v1, s[16:19], s60 offen offset:128 nt
    s_waitcnt vmcnt(7)
    s_add_u32 s60, s58, 18432
    buffer_load_dwordx4 v[144:147], v1, s[16:19], s60 offen offset:256 nt
    s_waitcnt vmcnt(7)
    s_add_u32 s60, s58, 18432
    buffer_load_dwordx4 v[148:151], v1, s[16:19], s60 offen offset:3072 nt
    s_waitcnt vmcnt(7)
    s_add_u32 s60, s58, 18432
    buffer_load_dwordx4 v[152:155], v1, s[16:19], s60 offen offset:3200 nt
    s_waitcnt vmcnt(7)
    s_add_u32 s60, s58, 18432
    buffer_load_dwordx4 v[156:159], v1, s[16:19], s60 offen offset:3328 nt
    s_waitcnt vmcnt(7)
    s_cmp_lg_u32 s81, 0
    s_cbranch_scc1 Ls_32
    s_call_b64 s[70:71], Lcissue
Ls_32:
    s_cmp_lg_u32 s81, 0
    s_cbranch_scc1 Ls_33
    buffer_load_dwordx4 v[200:203], v2, s[20:23], s58 offen offset:1280 nt
    s_waitcnt vmcnt(17)
    buffer_load_dwordx4 v[204:207], v2, s[20:23], s58 offen offset:1408 nt
    s_waitcnt vmcnt(17)
    buffer_load_dwordx4 v[208:211], v2, s[20:23], s58 offen offset:1536 nt
    s_waitcnt vmcnt(17)
    buffer_load_dwordx4 v[212:215], v2, s[20:23], s58 offen offset:1664 nt
    s_waitcnt vmcnt(17)
    buffer_load_dwordx4 v[216:219], v2, s[20:23], s58 offen offset:1792 nt
    s_waitcnt vmcnt(17)
    buffer_load_dwordx4 v[220:223], v2, s[20:23], s58 offen offset:1920 nt
    s_waitcnt vmcnt(17)
    buffer_load_dwordx4 v[224:227], v2, s[20:23], s58 offen offset:2048 nt
    s_waitcnt vmcnt(17)
    s_waitcnt vmcnt(7)
    s_mov_b32 s35, 1
    s_call_b64 s[72:73], Lccheck
    s_mov_b32 s35, 0
    s_branch Ls_34
Ls_33:
    buffer_load_dwordx4 v[200:203], v2, s[20:23], s58 offen offset:1280 nt
    s_waitcnt vmcnt(7)
    buffer_load_dwordx4 v[204:207], v2, s[20:23], s58 offen offset:1408 nt
    s_waitcnt vmcnt(7)
    buffer_load_dwordx4 v[208:211], v2, s[20:23], s58 offen offset:1536 nt
    s_waitcnt vmcnt(7)
    buffer_load_dwordx4 v[212:215], v2, s[20:23], s58 offen offset:1664 nt
    s_waitcnt vmcnt(7)
    buffer_load_dwordx4 v[216:219], v2, s[20:23], s58 offen offset:1792 nt
    s_waitcnt vmcnt(7)
    buffer_load_dwordx4 v[220:223], v2, s[20:23], s58 offen offset:1920 nt
    s_waitcnt vmcnt(7)
    buffer_load_dwordx4 v[224:227], v2, s[20:23], s58 offen offset:2048 nt
    s_waitcnt vmcnt(7)
Ls_34:
    buffer_load_dwordx4 v[228:231], v2, s[20:23], s58 offen offset:2176 nt
    buffer_load_dwordx4 v[232:235], v2, s[20:23], s58 offen offset:2304 nt
    buffer_load_dwordx4 v[236:239], v2, s[20:23], s58 offen offset:2432 nt
    buffer_load_dwordx4 v[240:243], v2, s[20:23], s58 offen offset:2560 nt
    buffer_load_dwordx4 v[244:247], v2, s[20:23], s58 offen offset:2688 nt
    buffer_load_dwordx4 v[248:251], v2, s[20:23], s58 offen offset:2816 nt
    buffer_load_dwordx4 v[252:255], v2, s[20:23], s58 offen offset:2944 nt
    s_cmp_lg_u32 s81, 0
    s_cbranch_scc1 Ls_35
    s_call_b64 s[72:73], Lcretry
Ls_35:
    s_cmp_lg_u32 s7, 0
    s_cbranch_scc1 Ls_36
    v_lshrrev_b32 v53, 7, v0
    v_mul_u32_u24 v53, 1280, v53
    v_and_b32 v52, 0x70, v0
    v_or_b32 v52, v52, v53
    v_bfe_u32 v53, v0, 8, 1
    v_lshlrev_b32 v53, 5, v53
    v_xor_b32 v52, v52, v53
    v_xor_b32 v53, 64, v52
    s_lshr_b32 s64, s4, 1
    s_lshl_b32 s64, s64, 7
    s_mul_i32 s65, s75, 163840
    s_add_u32 s64, s64, s65
    s_lshl_b32 m0, s4, 14
    s_nop 0
    buffer_load_dwordx4 v52, s[28:31], s64 offen nt lds
    s_add_u32 m0, m0, 1024
    s_add_u32 s64, s64, 10240
    buffer_load_dwordx4 v53, s[28:31], s64 offen nt lds
    s_add_u32 m0, m0, 1024
    s_add_u32 s64, s64, 10240
    buffer_load_dwordx4 v52, s[28:31], s64 offen nt lds
    s_add_u32 m0, m0, 1024
    s_add_u32 s64, s64, 10240
    buffer_load_dwordx4 v53, s[28:31], s64 offen nt lds
    s_add_u32 m0, m0, 1024
    s_add_u32 s64, s64, 10240
    buffer_load_dwordx4 v52, s[28:31], s64 offen nt lds
    s_add_u32 m0, m0, 1024
    s_add_u32 s64, s64, 10240
    buffer_load_dwordx4 v53, s[28:31], s64 offen nt lds
    s_add_u32 m0, m0, 1024
    s_add_u32 s64, s64, 10240
    buffer_load_dwordx4 v52, s[28:31], s64 offen nt lds
    s_add_u32 m0, m0, 1024
    s_add_u32 s64, s64, 10240
    buffer_load_dwordx4 v53, s[28:31], s64 offen nt lds
    s_add_u32 m0, m0, 1024
    s_add_u32 s64, s64, 10240
    buffer_load_dwordx4 v52, s[28:31], s64 offen nt lds
    s_add_u32 m0, m0, 1024
    s_add_u32 s64, s64, 10240
    buffer_load_dwordx4 v53, s[28:31], s64 offen nt lds
    s_add_u32 m0, m0, 1024
    s_add_u32 s64, s64, 10240
    buffer_load_dwordx4 v52, s[28:31], s64 offen nt lds
    s_add_u32 m0, m0, 1024
    s_add_u32 s64, s64, 10240
    buffer_load_dwordx4 v53, s[28:31], s64 offen nt lds
    s_add_u32 m0, m0, 1024
    s_add_u32 s64, s64, 10240
    buffer_load_dwordx4 v52, s[28:31], s64 offen nt lds
    s_add_u32 m0, m0, 1024
    s_add_u32 s64, s64, 10240
    buffer_load_dwordx4 v53, s[28:31], s64 offen nt lds
    s_add_u32 m0, m0, 1024
    s_add_u32 s64, s64, 10240
    buffer_load_dwordx4 v52, s[28:31], s64 offen nt lds
    s_add_u32 m0, m0, 1024
    s_add_u32 s64, s64, 10240
    buffer_load_dwordx4 v53, s[28:31], s64 offen nt lds
    s_branch Ls_38
Ls_36:
Ls_38:
    s_add_u32 s5, s5, 1
    s_add_u32 s82, s82, 4
    s_barrier
    v_lshrrev_b32 v40, 7, v0
    v_lshlrev_b32 v40, 4, v40
    v_add_u32 v40, 162560, v40
    ds_read_b128 v[12:15], v40 offset:0
    ds_read_b128 v[16:19], v40 offset:128
    ds_read_b128 v[20:23], v40 offset:256
    s_waitcnt vmcnt(30)
    s_cmp_eq_u32 s7, 0
    s_cbranch_scc1 Ls_39
    s_waitcnt vmcnt(14)
Ls_39:
    s_waitcnt lgkmcnt(0)
    v_mfma_f32_16x16x32_bf16 v[24:27], v[12:15], a[192:195], 0
    v_mfma_f32_16x16x32_bf16 v[24:27], v[16:19], a[196:199], v[24:27]
    v_mfma_f32_16x16x32_bf16 v[24:27], v[20:23], a[200:203], v[24:27]
    v_mfma_f32_16x16x32_bf16 v[28:31], v[12:15], a[216:219], 0
    v_mfma_f32_16x16x32_bf16 v[28:31], v[16:19], a[220:223], v[28:31]
    v_mfma_f32_16x16x32_bf16 v[28:31], v[20:23], a[224:227], v[28:31]
    v_mfma_f32_16x16x32_bf16 v[32:35], v[12:15], a[240:243], 0
    v_mfma_f32_16x16x32_bf16 v[32:35], v[16:19], a[244:247], v[32:35]
    v_mfma_f32_16x16x32_bf16 v[32:35], v[20:23], a[248:251], v[32:35]
    v_mfma_f32_16x16x32_bf16 v[36:39], v[12:15], v[136:139], 0
    v_mfma_f32_16x16x32_bf16 v[36:39], v[16:19], v[140:143], v[36:39]
    v_mfma_f32_16x16x32_bf16 v[36:39], v[20:23], v[144:147], v[36:39]
    v_mov_b32 v40, v24
    v_mfma_f32_16x16x32_bf16 v[24:27], v[12:15], a[204:207], 0
    v_mfma_f32_16x16x32_bf16 v[24:27], v[16:19], a[208:211], v[24:27]
    v_mfma_f32_16x16x32_bf16 v[24:27], v[20:23], a[212:215], v[24:27]
    v_mov_b32_dpp v40, v28 quad_perm:[0,1,2,3] row_mask:0xa bank_mask:0xf
    v_mfma_f32_16x16x32_bf16 v[28:31], v[12:15], a[228:231], 0
    v_mfma_f32_16x16x32_bf16 v[28:31], v[16:19], a[232:235], v[28:31]
    v_mfma_f32_16x16x32_bf16 v[28:31], v[20:23], a[236:239], v[28:31]
    v_mov_b32 v41, v32
    v_mfma_f32_16x16x32_bf16 v[32:35], v[12:15], a[252:255], 0
    v_mfma_f32_16x16x32_bf16 v[32:35], v[16:19], v[128:131], v[32:35]
    v_mfma_f32_16x16x32_bf16 v[32:35], v[20:23], v[132:135], v[32:35]
    v_mov_b32_dpp v41, v36 quad_perm:[0,1,2,3] row_mask:0xa bank_mask:0xf
    v_mfma_f32_16x16x32_bf16 v[36:39], v[12:15], v[148:151], 0
    v_mfma_f32_16x16x32_bf16 v[36:39], v[16:19], v[152:155], v[36:39]
    v_permlane32_swap_b32 v40, v41
    v_mfma_f32_16x16x32_bf16 v[36:39], v[20:23], v[156:159], v[36:39]
    s_nop 0
    v_add_f32_dpp v44, v41, v40 row_ror:8 row_mask:0xf bank_mask:0x3
    v_mov_b32 v42, v24
    s_nop 1
    v_mov_b32_dpp v42, v28 quad_perm:[0,1,2,3] row_mask:0xa bank_mask:0xf
    v_mov_b32 v43, v32
    s_nop 1
    v_mov_b32_dpp v43, v36 quad_perm:[0,1,2,3] row_mask:0xa bank_mask:0xf
    s_nop 1
    v_permlane32_swap_b32 v42, v43
    s_nop 1
    v_add_f32_dpp v44, v42, v43 row_ror:8 row_mask:0xf bank_mask:0xc
    s_nop 1
    v_max_f32_dpp v39, v44, v44 row_ror:8 row_mask:0xf bank_mask:0xf
    v_mov_b32 v38, s82
    s_nop 0
    v_max_f32_dpp v39, v39, v39 row_ror:4 row_mask:0xf bank_mask:0xf
    s_nop 1
    v_max_f32_dpp v39, v39, v39 row_ror:2 row_mask:0xf bank_mask:0xf
    s_nop 1
    v_max_f32_dpp v39, v39, v39 row_ror:1 row_mask:0xf bank_mask:0xf
    s_mov_b32 exec_lo, 0x10001
    s_mov_b32 exec_hi, 0x10001
    ds_max_f32 v38, v39
    s_mov_b64 exec, -1
    s_waitcnt lgkmcnt(0)
    s_barrier
    ds_read_b32 v39, v38
    s_waitcnt lgkmcnt(0)
    v_mul_f32 v39, s84, v39
    v_fma_f32 v44, v44, s84, -v39
    v_exp_f32 v44, v44
    s_nop 1
    v_mov_b32_dpp v40, v44 row_ror:8 row_mask:0xf bank_mask:0xf
    v_mov_b32 v38, v44
    v_cvt_pk_bf16_f32 v44, v44, v40
    s_nop 0
    v_add_f32_dpp v38, v38, v38 row_ror:8 row_mask:0xf bank_mask:0xf
    s_nop 1
    v_add_f32_dpp v38, v38, v38 row_ror:4 row_mask:0xf bank_mask:0xf
    s_nop 1
    v_add_f32_dpp v38, v38, v38 row_ror:2 row_mask:0xf bank_mask:0xf
    s_nop 1
    v_add_f32_dpp v38, v38, v38 row_ror:1 row_mask:0xf bank_mask:0xf
    v_mov_b32 v37, v38
    s_nop 1
    v_permlane32_swap_b32 v38, v37
    v_add_f32 v38, v38, v37
    v_mov_b32 v37, v38
    s_nop 1
    v_permlane16_swap_b32 v38, v37
    v_add_f32 v38, v38, v37
    s_lshl_b32 s60, s4, 2
    s_add_u32 s60, s60, 162960
    v_mov_b32 v37, s60
    s_mov_b64 exec, 1
    ds_write_b32 v37, v38
    s_mov_b64 exec, -1
    v_mov_b32_dpp v36, v44 row_newbcast:0 row_mask:0xf bank_mask:0xf
    v_perm_b32 v12, v36, v36, v4
    v_perm_b32 v13, v36, v36, v5
    v_perm_b32 v14, v36, v36, v6
    v_perm_b32 v15, v36, v36, v7
    s_nop 1
    v_mfma_f32_16x16x32_bf16 v[24:27], v[12:15], v[160:163], 0
    v_mov_b32_dpp v36, v44 row_newbcast:1 row_mask:0xf bank_mask:0xf
    v_perm_b32 v16, v36, v36, v4
    v_mfma_f32_16x16x32_bf16 v[28:31], v[12:15], v[164:167], 0
    v_perm_b32 v17, v36, v36, v5
    v_perm_b32 v18, v36, v36, v6
    v_perm_b32 v19, v36, v36, v7
    v_mfma_f32_16x16x32_bf16 v[32:35], v[12:15], v[168:171], 0
    s_nop 0
    v_mfma_f32_16x16x32_bf16 v[24:27], v[16:19], v[172:175], v[24:27]
    v_mov_b32_dpp v36, v44 row_newbcast:2 row_mask:0xf bank_mask:0xf
    v_perm_b32 v12, v36, v36, v4
    v_mfma_f32_16x16x32_bf16 v[28:31], v[16:19], v[176:179], v[28:31]
    v_perm_b32 v13, v36, v36, v5
    v_perm_b32 v14, v36, v36, v6
    v_perm_b32 v15, v36, v36, v7
    v_mfma_f32_16x16x32_bf16 v[32:35], v[16:19], v[180:183], v[32:35]
    s_nop 0
    v_mfma_f32_16x16x32_bf16 v[24:27], v[12:15], v[184:187], v[24:27]
    v_mov_b32_dpp v36, v44 row_newbcast:3 row_mask:0xf bank_mask:0xf
    v_perm_b32 v16, v36, v36, v4
    v_mfma_f32_16x16x32_bf16 v[28:31], v[12:15], v[188:191], v[28:31]
    v_perm_b32 v17, v36, v36, v5
    v_perm_b32 v18, v36, v36, v6
    v_perm_b32 v19, v36, v36, v7
    v_mfma_f32_16x16x32_bf16 v[32:35], v[12:15], v[192:195], v[32:35]
    s_waitcnt vmcnt(25)
    s_cmp_eq_u32 s7, 0
    s_cbranch_scc1 Ls_40
    s_waitcnt vmcnt(9)
Ls_40:
    s_nop 0
    v_mfma_f32_16x16x32_bf16 v[24:27], v[16:19], v[196:199], v[24:27]
    v_mov_b32_dpp v36, v44 row_newbcast:4 row_mask:0xf bank_mask:0xf
    v_perm_b32 v12, v36, v36, v4
    v_mfma_f32_16x16x32_bf16 v[28:31], v[16:19], v[200:203], v[28:31]
    v_perm_b32 v13, v36, v36, v5
    v_perm_b32 v14, v36, v36, v6
    v_perm_b32 v15, v36, v36, v7
    v_mfma_f32_16x16x32_bf16 v[32:35], v[16:19], v[204:207], v[32:35]
    s_nop 0
    v_mfma_f32_16x16x32_bf16 v[24:27], v[12:15], v[208:211], v[24:27]
    v_mov_b32_dpp v36, v44 row_newbcast:5 row_mask:0xf bank_mask:0xf
    v_perm_b32 v16, v36, v36, v4
    v_mfma_f32_16x16x32_bf16 v[28:31], v[12:15], v[212:215], v[28:31]
    v_perm_b32 v17, v36, v36, v5
    v_perm_b32 v18, v36, v36, v6
    v_perm_b32 v19, v36, v36, v7
    v_mfma_f32_16x16x32_bf16 v[32:35], v[12:15], v[216:219], v[32:35]
    s_waitcnt vmcnt(22)
    s_cmp_eq_u32 s7, 0
    s_cbranch_scc1 Ls_41
    s_waitcnt vmcnt(6)
Ls_41:
    s_nop 0
    v_mfma_f32_16x16x32_bf16 v[24:27], v[16:19], v[220:223], v[24:27]
    v_mov_b32_dpp v36, v44 row_newbcast:6 row_mask:0xf bank_mask:0xf
    v_perm_b32 v12, v36, v36, v4
    v_mfma_f32_16x16x32_bf16 v[28:31], v[16:19], v[224:227], v[28:31]
    v_perm_b32 v13, v36, v36, v5
    v_perm_b32 v14, v36, v36, v6
    v_perm_b32 v15, v36, v36, v7
    v_mfma_f32_16x16x32_bf16 v[32:35], v[16:19], v[228:231], v[32:35]
    s_waitcnt vmcnt(19)
    s_cmp_eq_u32 s7, 0
    s_cbranch_scc1 Ls_42
    s_waitcnt vmcnt(3)
Ls_42:
    s_nop 0
    v_mfma_f32_16x16x32_bf16 v[24:27], v[12:15], v[232:235], v[24:27]
    v_mov_b32_dpp v36, v44 row_newbcast:7 row_mask:0xf bank_mask:0xf
    v_perm_b32 v16, v36, v36, v4
    v_mfma_f32_16x16x32_bf16 v[28:31], v[12:15], v[236:239], v[28:31]
    v_perm_b32 v17, v36, v36, v5
    v_perm_b32 v18, v36, v36, v6
    v_perm_b32 v19, v36, v36, v7
    v_mfma_f32_16x16x32_bf16 v[32:35], v[12:15], v[240:243], v[32:35]
    s_waitcnt vmcnt(16)
    s_cmp_eq_u32 s7, 0
    s_cbranch_scc1 Ls_43
    s_waitcnt vmcnt(0)
Ls_43:
    s_nop 0
    v_mfma_f32_16x16x32_bf16 v[24:27], v[16:19], v[244:247], v[24:27]
    v_mfma_f32_16x16x32_bf16 v[28:31], v[16:19], v[248:251], v[28:31]
    v_mfma_f32_16x16x32_bf16 v[32:35], v[16:19], v[252:255], v[32:35]
    s_nop 7
    s_call_b64 s[70:71], Lepi
    s_cmp_eq_u32 s7, 1
    s_cbranch_scc1 LfQ
    s_cmp_eq_u32 s7, 2
    s_cbranch_scc1 Lend
    s_call_b64 s[70:71], LpollA
    s_call_b64 s[70:71], Loproj
    s_branch Lend
LfQ:
    s_cmp_lg_u32 s55, 0
    s_cbranch_scc1 Lend
    s_call_b64 s[70:71], LpollB
Lend:
Lexit:
    s_endpgm
Lqka:
    v_lshrrev_b32 v40, 7, v0
    v_lshlrev_b32 v40, 4, v40
    v_add_u32 v40, 162560, v40
    ds_read_b128 v[12:15], v40 offset:0
    ds_read_b128 v[16:19], v40 offset:128
    ds_read_b128 v[20:23], v40 offset:256
    s_waitcnt lgkmcnt(0)
    v_mfma_f32_16x16x32_bf16 v[24:27], v[12:15], a[0:3], 0
    v_mfma_f32_16x16x32_bf16 v[24:27], v[16:19], a[4:7], v[24:27]
    v_mfma_f32_16x16x32_bf16 v[24:27], v[20:23], a[8:11], v[24:27]
    v_mfma_f32_16x16x32_bf16 v[28:31], v[12:15], a[24:27], 0
    v_mfma_f32_16x16x32_bf16 v[28:31], v[16:19], a[28:31], v[28:31]
    v_mfma_f32_16x16x32_bf16 v[28:31], v[20:23], a[32:35], v[28:31]
    v_mfma_f32_16x16x32_bf16 v[32:35], v[12:15], a[48:51], 0
    v_mfma_f32_16x16x32_bf16 v[32:35], v[16:19], a[52:55], v[32:35]
    v_mfma_f32_16x16x32_bf16 v[32:35], v[20:23], a[56:59], v[32:35]
    v_mfma_f32_16x16x32_bf16 v[36:39], v[12:15], a[72:75], 0
    v_mfma_f32_16x16x32_bf16 v[36:39], v[16:19], a[76:79], v[36:39]
    v_mfma_f32_16x16x32_bf16 v[36:39], v[20:23], a[80:83], v[36:39]
    v_mov_b32 v40, v24
    v_mfma_f32_16x16x32_bf16 v[24:27], v[12:15], a[12:15], 0
    v_mfma_f32_16x16x32_bf16 v[24:27], v[16:19], a[16:19], v[24:27]
    v_mfma_f32_16x16x32_bf16 v[24:27], v[20:23], a[20:23], v[24:27]
    v_mov_b32_dpp v40, v28 quad_perm:[0,1,2,3] row_mask:0xa bank_mask:0xf
    v_mfma_f32_16x16x32_bf16 v[28:31], v[12:15], a[36:39], 0
    v_mfma_f32_16x16x32_bf16 v[28:31], v[16:19], a[40:43], v[28:31]
    v_mfma_f32_16x16x32_bf16 v[28:31], v[20:23], a[44:47], v[28:31]
    v_mov_b32 v41, v32
    v_mfma_f32_16x16x32_bf16 v[32:35], v[12:15], a[60:63], 0
    v_mfma_f32_16x16x32_bf16 v[32:35], v[16:19], a[64:67], v[32:35]
    v_mfma_f32_16x16x32_bf16 v[32:35], v[20:23], a[68:71], v[32:35]
    v_mov_b32_dpp v41, v36 quad_perm:[0,1,2,3] row_mask:0xa bank_mask:0xf
    v_mfma_f32_16x16x32_bf16 v[36:39], v[12:15], a[84:87], 0
    v_mfma_f32_16x16x32_bf16 v[36:39], v[16:19], a[88:91], v[36:39]
    v_permlane32_swap_b32 v40, v41
    v_mfma_f32_16x16x32_bf16 v[36:39], v[20:23], a[92:95], v[36:39]
    s_nop 0
    v_add_f32_dpp v44, v41, v40 row_ror:8 row_mask:0xf bank_mask:0x3
    v_mov_b32 v42, v24
    s_cmp_eq_u32 s5, 0
    s_cbranch_scc1 Ls_44
    s_add_u32 s63, s57, 24576
    buffer_load_dwordx4 a[0:3], v2, s[12:15], s63 offen offset:1920 nt
    buffer_load_dwordx4 a[4:7], v2, s[12:15], s63 offen offset:2048 nt
    buffer_load_dwordx4 a[8:11], v2, s[12:15], s63 offen offset:2176 nt
    s_add_u32 s63, s57, 49152
    buffer_load_dwordx4 a[12:15], v2, s[12:15], s63 offen offset:1536 nt
    buffer_load_dwordx4 a[16:19], v2, s[12:15], s63 offen offset:1664 nt
    buffer_load_dwordx4 a[20:23], v2, s[12:15], s63 offen offset:1792 nt
    s_add_u32 s63, s57, 24576
    buffer_load_dwordx4 a[24:27], v2, s[12:15], s63 offen offset:2304 nt
    buffer_load_dwordx4 a[28:31], v2, s[12:15], s63 offen offset:2432 nt
    buffer_load_dwordx4 a[32:35], v2, s[12:15], s63 offen offset:2560 nt
Ls_44:
    v_mfma_f32_16x16x32_bf16 v[24:27], v[12:15], a[96:99], 0
    v_mfma_f32_16x16x32_bf16 v[24:27], v[16:19], a[100:103], v[24:27]
    v_mfma_f32_16x16x32_bf16 v[24:27], v[20:23], a[104:107], v[24:27]
    v_mov_b32_dpp v42, v28 quad_perm:[0,1,2,3] row_mask:0xa bank_mask:0xf
    v_mfma_f32_16x16x32_bf16 v[28:31], v[12:15], a[120:123], 0
    v_mfma_f32_16x16x32_bf16 v[28:31], v[16:19], a[124:127], v[28:31]
    v_mfma_f32_16x16x32_bf16 v[28:31], v[20:23], a[128:131], v[28:31]
    v_mov_b32 v43, v32
    v_mfma_f32_16x16x32_bf16 v[32:35], v[12:15], a[144:147], 0
    v_mfma_f32_16x16x32_bf16 v[32:35], v[16:19], a[148:151], v[32:35]
    v_mfma_f32_16x16x32_bf16 v[32:35], v[20:23], a[152:155], v[32:35]
    v_mov_b32_dpp v43, v36 quad_perm:[0,1,2,3] row_mask:0xa bank_mask:0xf
    v_mfma_f32_16x16x32_bf16 v[36:39], v[12:15], a[168:171], 0
    v_mfma_f32_16x16x32_bf16 v[36:39], v[16:19], a[172:175], v[36:39]
    v_permlane32_swap_b32 v42, v43
    v_mfma_f32_16x16x32_bf16 v[36:39], v[20:23], a[176:179], v[36:39]
    s_nop 0
    v_add_f32_dpp v44, v42, v43 row_ror:8 row_mask:0xf bank_mask:0xc
    v_mov_b32 v40, v24
    v_mfma_f32_16x16x32_bf16 v[24:27], v[12:15], a[108:111], 0
    v_mfma_f32_16x16x32_bf16 v[24:27], v[16:19], a[112:115], v[24:27]
    v_mfma_f32_16x16x32_bf16 v[24:27], v[20:23], a[116:119], v[24:27]
    v_mov_b32_dpp v40, v28 quad_perm:[0,1,2,3] row_mask:0xa bank_mask:0xf
    v_mfma_f32_16x16x32_bf16 v[28:31], v[12:15], a[132:135], 0
    v_mfma_f32_16x16x32_bf16 v[28:31], v[16:19], a[136:139], v[28:31]
    v_mfma_f32_16x16x32_bf16 v[28:31], v[20:23], a[140:143], v[28:31]
    v_mov_b32 v41, v32
    v_mfma_f32_16x16x32_bf16 v[32:35], v[12:15], a[156:159], 0
    v_mfma_f32_16x16x32_bf16 v[32:35], v[16:19], a[160:163], v[32:35]
    v_mfma_f32_16x16x32_bf16 v[32:35], v[20:23], a[164:167], v[32:35]
    v_mov_b32_dpp v41, v36 quad_perm:[0,1,2,3] row_mask:0xa bank_mask:0xf
    v_mfma_f32_16x16x32_bf16 v[36:39], v[12:15], a[180:183], 0
    v_mfma_f32_16x16x32_bf16 v[36:39], v[16:19], a[184:187], v[36:39]
    v_permlane32_swap_b32 v40, v41
    v_mfma_f32_16x16x32_bf16 v[36:39], v[20:23], a[188:191], v[36:39]
    s_nop 0
    v_add_f32_dpp v45, v41, v40 row_ror:8 row_mask:0xf bank_mask:0x3
    v_mov_b32 v42, v24
    v_mfma_f32_16x16x32_bf16 v[24:27], v[12:15], a[192:195], 0
    v_mfma_f32_16x16x32_bf16 v[24:27], v[16:19], a[196:199], v[24:27]
    v_mfma_f32_16x16x32_bf16 v[24:27], v[20:23], a[200:203], v[24:27]
    v_mov_b32_dpp v42, v28 quad_perm:[0,1,2,3] row_mask:0xa bank_mask:0xf
    v_mfma_f32_16x16x32_bf16 v[28:31], v[12:15], a[216:219], 0
    v_mfma_f32_16x16x32_bf16 v[28:31], v[16:19], a[220:223], v[28:31]
    v_mfma_f32_16x16x32_bf16 v[28:31], v[20:23], a[224:227], v[28:31]
    v_mov_b32 v43, v32
    v_mfma_f32_16x16x32_bf16 v[32:35], v[12:15], a[240:243], 0
    v_mfma_f32_16x16x32_bf16 v[32:35], v[16:19], a[244:247], v[32:35]
    v_mfma_f32_16x16x32_bf16 v[32:35], v[20:23], a[248:251], v[32:35]
    v_mov_b32_dpp v43, v36 quad_perm:[0,1,2,3] row_mask:0xa bank_mask:0xf
    v_mfma_f32_16x16x32_bf16 v[36:39], v[12:15], v[136:139], 0
    v_mfma_f32_16x16x32_bf16 v[36:39], v[16:19], v[140:143], v[36:39]
    v_permlane32_swap_b32 v42, v43
    v_mfma_f32_16x16x32_bf16 v[36:39], v[20:23], v[144:147], v[36:39]
    s_nop 0
    v_add_f32_dpp v45, v42, v43 row_ror:8 row_mask:0xf bank_mask:0xc
    v_mov_b32 v40, v24
    v_mfma_f32_16x16x32_bf16 v[24:27], v[12:15], a[204:207], 0
    v_mfma_f32_16x16x32_bf16 v[24:27], v[16:19], a[208:211], v[24:27]
    v_mfma_f32_16x16x32_bf16 v[24:27], v[20:23], a[212:215], v[24:27]
    v_mov_b32_dpp v40, v28 quad_perm:[0,1,2,3] row_mask:0xa bank_mask:0xf
    v_mfma_f32_16x16x32_bf16 v[28:31], v[12:15], a[228:231], 0
    v_mfma_f32_16x16x32_bf16 v[28:31], v[16:19], a[232:235], v[28:31]
    v_mfma_f32_16x16x32_bf16 v[28:31], v[20:23], a[236:239], v[28:31]
    v_mov_b32 v41, v32
    v_mfma_f32_16x16x32_bf16 v[32:35], v[12:15], a[252:255], 0
    v_mfma_f32_16x16x32_bf16 v[32:35], v[16:19], v[128:131], v[32:35]
    v_mfma_f32_16x16x32_bf16 v[32:35], v[20:23], v[132:135], v[32:35]
    v_mov_b32_dpp v41, v36 quad_perm:[0,1,2,3] row_mask:0xa bank_mask:0xf
    v_mfma_f32_16x16x32_bf16 v[36:39], v[12:15], v[148:151], 0
    v_mfma_f32_16x16x32_bf16 v[36:39], v[16:19], v[152:155], v[36:39]
    v_permlane32_swap_b32 v40, v41
    v_mfma_f32_16x16x32_bf16 v[36:39], v[20:23], v[156:159], v[36:39]
    s_nop 0
    v_add_f32_dpp v46, v41, v40 row_ror:8 row_mask:0xf bank_mask:0x3
    v_mov_b32 v42, v24
    v_mfma_f32_16x16x32_bf16 v[24:27], v[12:15], v[160:163], 0
    v_mfma_f32_16x16x32_bf16 v[24:27], v[16:19], v[164:167], v[24:27]
    v_mfma_f32_16x16x32_bf16 v[24:27], v[20:23], v[168:171], v[24:27]
    v_mov_b32_dpp v42, v28 quad_perm:[0,1,2,3] row_mask:0xa bank_mask:0xf
    v_mfma_f32_16x16x32_bf16 v[28:31], v[12:15], v[184:187], 0
    v_mfma_f32_16x16x32_bf16 v[28:31], v[16:19], v[188:191], v[28:31]
    v_mfma_f32_16x16x32_bf16 v[28:31], v[20:23], v[192:195], v[28:31]
    v_mov_b32 v43, v32
    v_mfma_f32_16x16x32_bf16 v[32:35], v[12:15], v[208:211], 0
    v_mfma_f32_16x16x32_bf16 v[32:35], v[16:19], v[212:215], v[32:35]
    v_mfma_f32_16x16x32_bf16 v[32:35], v[20:23], v[216:219], v[32:35]
    v_mov_b32_dpp v43, v36 quad_perm:[0,1,2,3] row_mask:0xa bank_mask:0xf
    v_mfma_f32_16x16x32_bf16 v[36:39], v[12:15], v[232:235], 0
    v_mfma_f32_16x16x32_bf16 v[36:39], v[16:19], v[236:239], v[36:39]
    v_permlane32_swap_b32 v42, v43
    v_mfma_f32_16x16x32_bf16 v[36:39], v[20:23], v[240:243], v[36:39]
    s_nop 0
    v_add_f32_dpp v46, v42, v43 row_ror:8 row_mask:0xf bank_mask:0xc
    v_mov_b32 v40, v24
    v_mfma_f32_16x16x32_bf16 v[24:27], v[12:15], v[172:175], 0
    v_mfma_f32_16x16x32_bf16 v[24:27], v[16:19], v[176:179], v[24:27]
    v_mfma_f32_16x16x32_bf16 v[24:27], v[20:23], v[180:183], v[24:27]
    v_mov_b32_dpp v40, v28 quad_perm:[0,1,2,3] row_mask:0xa bank_mask:0xf
    v_mfma_f32_16x16x32_bf16 v[28:31], v[12:15], v[196:199], 0
    v_mfma_f32_16x16x32_bf16 v[28:31], v[16:19], v[200:203], v[28:31]
    v_mfma_f32_16x16x32_bf16 v[28:31], v[20:23], v[204:207], v[28:31]
    v_mov_b32 v41, v32
    v_mfma_f32_16x16x32_bf16 v[32:35], v[12:15], v[220:223], 0
    v_mfma_f32_16x16x32_bf16 v[32:35], v[16:19], v[224:227], v[32:35]
    v_mfma_f32_16x16x32_bf16 v[32:35], v[20:23], v[228:231], v[32:35]
    v_mov_b32_dpp v41, v36 quad_perm:[0,1,2,3] row_mask:0xa bank_mask:0xf
    v_mfma_f32_16x16x32_bf16 v[36:39], v[12:15], v[244:247], 0
    v_mfma_f32_16x16x32_bf16 v[36:39], v[16:19], v[248:251], v[36:39]
    v_permlane32_swap_b32 v40, v41
    v_mfma_f32_16x16x32_bf16 v[36:39], v[20:23], v[252:255], v[36:39]
    s_nop 0
    v_add_f32_dpp v47, v41, v40 row_ror:8 row_mask:0xf bank_mask:0x3
    v_mov_b32 v42, v24
    s_nop 1
    v_mov_b32_dpp v42, v28 quad_perm:[0,1,2,3] row_mask:0xa bank_mask:0xf
    v_mov_b32 v43, v32
    s_nop 1
    v_mov_b32_dpp v43, v36 quad_perm:[0,1,2,3] row_mask:0xa bank_mask:0xf
    s_nop 1
    v_permlane32_swap_b32 v42, v43
    s_nop 1
    v_add_f32_dpp v47, v42, v43 row_ror:8 row_mask:0xf bank_mask:0xc
    v_max_f32 v39, v44, v45
    v_max3_f32 v39, v46, v47, v39
    s_nop 1
    v_max_f32_dpp v39, v39, v39 row_ror:8 row_mask:0xf bank_mask:0xf
    v_mov_b32 v38, s82
    s_nop 0
    v_max_f32_dpp v39, v39, v39 row_ror:4 row_mask:0xf bank_mask:0xf
    s_nop 1
    v_max_f32_dpp v39, v39, v39 row_ror:2 row_mask:0xf bank_mask:0xf
    s_nop 1
    v_max_f32_dpp v39, v39, v39 row_ror:1 row_mask:0xf bank_mask:0xf
    s_mov_b32 exec_lo, 0x10001
    s_mov_b32 exec_hi, 0x10001
    ds_max_f32 v38, v39
    s_mov_b64 exec, -1
    s_waitcnt lgkmcnt(0)
    s_barrier
    ds_read_b32 v39, v38
    s_waitcnt lgkmcnt(0)
    v_mul_f32 v39, s84, v39
    v_fma_f32 v44, v44, s84, -v39
    v_fma_f32 v45, v45, s84, -v39
    v_fma_f32 v46, v46, s84, -v39
    v_fma_f32 v47, v47, s84, -v39
    v_exp_f32 v44, v44
    v_exp_f32 v45, v45
    v_exp_f32 v46, v46
    v_exp_f32 v47, v47
    v_mov_b32_dpp v40, v44 row_ror:8 row_mask:0xf bank_mask:0xf
    v_mov_b32_dpp v41, v45 row_ror:8 row_mask:0xf bank_mask:0xf
    v_mov_b32_dpp v42, v46 row_ror:8 row_mask:0xf bank_mask:0xf
    v_mov_b32_dpp v43, v47 row_ror:8 row_mask:0xf bank_mask:0xf
    v_add_f32 v38, v44, v45
    v_add_f32 v37, v46, v47
    v_add_f32 v38, v38, v37
    v_cvt_pk_bf16_f32 v44, v44, v40
    v_cvt_pk_bf16_f32 v45, v45, v41
    v_cvt_pk_bf16_f32 v46, v46, v42
    v_cvt_pk_bf16_f32 v47, v47, v43
    v_add_f32_dpp v38, v38, v38 row_ror:8 row_mask:0xf bank_mask:0xf
    s_nop 1
    v_add_f32_dpp v38, v38, v38 row_ror:4 row_mask:0xf bank_mask:0xf
    s_nop 1
    v_add_f32_dpp v38, v38, v38 row_ror:2 row_mask:0xf bank_mask:0xf
    s_nop 1
    v_add_f32_dpp v38, v38, v38 row_ror:1 row_mask:0xf bank_mask:0xf
    v_mov_b32 v37, v38
    s_nop 1
    v_permlane32_swap_b32 v38, v37
    v_add_f32 v38, v38, v37
    v_mov_b32 v37, v38
    s_nop 1
    v_permlane16_swap_b32 v38, v37
    v_add_f32 v38, v38, v37
    s_lshl_b32 s60, s4, 2
    s_add_u32 s60, s60, 162960
    v_mov_b32 v37, s60
    s_mov_b64 exec, 1
    ds_write_b32 v37, v38
    s_mov_b64 exec, -1
    s_setpc_b64 s[70:71]
Lepi:
    v_lshrrev_b32 v20, 9, v0
    v_mul_u32_u24 v20, 768, v20
    v_bfe_u32 v21, v0, 4, 3
    v_lshl_add_u32 v20, v21, 5, v20
    v_bfe_u32 v21, v0, 8, 1
    v_lshlrev_b32 v21, 4, v21
    s_mul_i32 s60, s4, 1536
    s_add_u32 s60, s60, 155648
    v_add3_u32 v20, v20, v21, s60
    s_mov_b32 exec_lo, 0x00ff00ff
    s_mov_b32 exec_hi, 0xff00ff00
    ds_write_b128 v20, v[24:27] offset:0
    ds_write_b128 v20, v[28:31] offset:256
    ds_write_b128 v20, v[32:35] offset:512
    s_mov_b64 exec, -1
    s_and_b32 s76, s5, 1
    s_sub_u32 s77, 0, s76
    v_add_u32 v20, 155648, v0
    v_mov_b32 v21, 162960
    s_waitcnt lgkmcnt(0)
    s_barrier
    s_cmp_lg_u32 s4, 2
    s_cbranch_scc1 Lepi1
    ds_read_b128 v[12:15], v21
    ds_read_b128 v[24:27], v20 offset:0
    ds_read_b128 v[28:31], v20 offset:768
    ds_read_b128 v[32:35], v20 offset:1536
    ds_read_b128 v[40:43], v20 offset:2304
    ds_read_b128 v[44:47], v20 offset:3072
    ds_read_b128 v[48:51], v20 offset:3840
    ds_read_b128 v[52:55], v20 offset:4608
    ds_read_b128 v[56:59], v20 offset:5376
    s_lshl_b32 s60, s54, 1
    s_add_u32 s60, s60, s53
    s_mul_i32 s60, s60, 24576
    s_mul_i32 s61, s52, 768
    s_add_u32 s60, s60, s61
    s_lshl_b32 s61, s3, 2
    s_add_u32 s61, s61, 196608
    s_waitcnt lgkmcnt(8)
    v_add_f32 v12, v12, v13
    v_add_f32 v14, v14, v15
    v_add_f32 v12, v12, v14
    v_rcp_f32 v14, v12
    v_log_f32 v13, v12
    s_waitcnt lgkmcnt(6)
    v_pk_add_f32 v[24:25], v[24:25], v[28:29]
    v_pk_add_f32 v[26:27], v[26:27], v[30:31]
    v_add_f32 v13, v13, v39
    v_and_or_b32 v13, v13, -2, s76
    s_waitcnt lgkmcnt(4)
    v_pk_add_f32 v[32:33], v[32:33], v[40:41]
    v_pk_add_f32 v[34:35], v[34:35], v[42:43]
    s_waitcnt lgkmcnt(2)
    v_pk_add_f32 v[44:45], v[44:45], v[48:49]
    v_pk_add_f32 v[46:47], v[46:47], v[50:51]
    v_pk_add_f32 v[24:25], v[24:25], v[32:33]
    v_pk_add_f32 v[26:27], v[26:27], v[34:35]
    s_waitcnt lgkmcnt(0)
    v_pk_add_f32 v[52:53], v[52:53], v[56:57]
    v_pk_add_f32 v[54:55], v[54:55], v[58:59]
    v_pk_add_f32 v[24:25], v[24:25], v[44:45]
    v_pk_add_f32 v[26:27], v[26:27], v[46:47]
    v_pk_add_f32 v[24:25], v[24:25], v[52:53]
    v_pk_add_f32 v[26:27], v[26:27], v[54:55]
    v_pk_mul_f32 v[24:25], v[24:25], v[14:15] op_sel_hi:[1,0]
    v_pk_mul_f32 v[26:27], v[26:27], v[14:15] op_sel_hi:[1,0]
    v_and_or_b32 v24, v24, -2, s76
    v_and_or_b32 v25, v25, -2, s76
    v_and_or_b32 v26, v26, -2, s76
    v_and_or_b32 v27, v27, -2, s76
    s_nop 1
    s_cmp_eq_u32 s6, 0
    s_cbranch_scc1 Lg_45
    s_mov_b32 exec_lo, -1
    s_mov_b32 exec_hi, 0xffff
    buffer_store_dwordx4 v[24:27], v0, s[40:43], s60 offen
    s_mov_b64 exec, 1
    buffer_store_dword v13, v0, s[40:43], s61 offen
    s_branch Lgx_46
Lg_45:
    s_mov_b32 exec_lo, -1
    s_mov_b32 exec_hi, 0xffff
    buffer_store_dwordx4 v[24:27], v0, s[40:43], s60 offen sc1
    s_mov_b64 exec, 1
    buffer_store_dword v13, v0, s[40:43], s61 offen sc1
Lgx_46:
    s_mov_b64 exec, -1
Lepi1:
    s_barrier
    s_setpc_b64 s[70:71]
LpollA:
    v_lshrrev_b32 v62, 8, v0
    v_bfe_u32 v63, v0, 6, 2
    v_lshlrev_b32 v60, 10, v62
    v_lshl_or_b32 v60, v63, 7, v60
    v_lshrrev_b32 v63, 1, v63
    v_and_b32 v64, 1, v62
    v_lshl_or_b32 v63, v64, 1, v63
    v_lshl_or_b32 v60, v63, 5, v60
    v_bfe_u32 v63, v0, 4, 2
    v_lshl_or_b32 v60, v63, 3, v60
    s_lshr_b32 s65, s4, 1
    s_lshl_b32 s65, s65, 15
    s_lshl_b32 s66, s75, 6
    s_add_u32 s65, s65, s66
    v_xor_b32 v60, s65, v60
    v_xor_b32 v61, 32, v60
    v_mul_u32_u24 v64, 6144, v64
    v_and_b32 v63, 0x70, v0
    v_add_u32 v64, v64, v63
    v_bfe_u32 v63, v0, 6, 1
    v_lshlrev_b32 v63, 9, v63
    v_lshl_add_u32 v62, v62, 4, v63
    v_add_u32 v62, 155648, v62
    s_lshl_b32 s65, s75, 9
    s_add_u32 s65, s65, 155648
    v_lshrrev_b32 v63, 1, v0
    v_add_u32 v63, s65, v63
    s_mul_i32 s60, s75, 24576
    s_lshl_b32 s61, s55, 10
    s_add_u32 s60, s60, s61
    s_add_u32 s61, s60, 49152
    s_add_u32 s62, s61, 49152
    s_add_u32 s63, s62, 49152
    s_lshl_b32 s64, s75, 4
    s_add_u32 s64, s64, 196608
    s_lshl_b32 s65, s55, 6
    v_lshrrev_b32 v32, 4, v0
    v_add_u32 v32, s65, v32
    v_mul_u32_u24 v32, 43691, v32
    v_lshrrev_b32 v32, 21, v32
    v_lshlrev_b32 v32, 5, v32
    s_waitcnt vmcnt(2)
    s_cmp_eq_u32 s4, 2
    s_cbranch_scc1 LpA1
    s_waitcnt vmcnt(0)
LpA1:
    s_barrier
    ds_read_b64_tr_b16 v[36:37], v60 offset:0
    ds_read_b64_tr_b16 v[38:39], v60 offset:512
    ds_read_b64_tr_b16 v[40:41], v61 offset:0
    ds_read_b64_tr_b16 v[42:43], v61 offset:512
    ds_read_b64_tr_b16 v[44:45], v60 offset:4096
    ds_read_b64_tr_b16 v[46:47], v60 offset:4608
    ds_read_b64_tr_b16 v[48:49], v61 offset:4096
    ds_read_b64_tr_b16 v[50:51], v61 offset:4608
    ds_read_b64_tr_b16 v[52:53], v60 offset:8192
    ds_read_b64_tr_b16 v[54:55], v60 offset:8704
    s_cmp_ge_u32 s4, 2
    s_cbranch_scc1 LpA2
    s_mov_b32 s59, 262144
Lp_47:
    buffer_load_dwordx4 v[12:15], v32, s[40:43], s64 offen offset:0 sc1
    buffer_load_dwordx4 v[16:19], v0, s[40:43], s60 offen offset:0 sc1
    buffer_load_dwordx4 v[20:23], v0, s[40:43], s61 offen offset:0 sc1
    buffer_load_dwordx4 v[24:27], v0, s[40:43], s62 offen offset:0 sc1
    buffer_load_dwordx4 v[28:31], v0, s[40:43], s63 offen offset:0 sc1
    s_waitcnt vmcnt(4)
    v_bitop3_b32 v10, v12, v13, s77 bitop3:0x7e
    v_bitop3_b32 v11, v14, v15, s77 bitop3:0x7e
    v_or_b32 v10, v10, v11
    s_waitcnt vmcnt(3)
    v_bitop3_b32 v11, v16, v17, s77 bitop3:0x7e
    v_bitop3_b32 v59, v18, v19, s77 bitop3:0x7e
    v_or3_b32 v10, v10, v11, v59
    s_waitcnt vmcnt(2)
    v_bitop3_b32 v11, v20, v21, s77 bitop3:0x7e
    v_bitop3_b32 v59, v22, v23, s77 bitop3:0x7e
    v_or3_b32 v10, v10, v11, v59
    s_waitcnt vmcnt(1)
    v_bitop3_b32 v11, v24, v25, s77 bitop3:0x7e
    v_bitop3_b32 v59, v26, v27, s77 bitop3:0x7e
    v_or3_b32 v10, v10, v11, v59
    s_waitcnt vmcnt(0)
    v_bitop3_b32 v11, v28, v29, s77 bitop3:0x7e
    v_bitop3_b32 v59, v30, v31, s77 bitop3:0x7e
    v_or3_b32 v10, v10, v11, v59
    v_and_b32 v10, 1, v10
    v_cmp_ne_u32 vcc, 0, v10
    s_sub_u32 s59, s59, 1
    s_cbranch_scc1 Lpx_48
    s_cbranch_vccnz Lp_47
Lpx_48:
    v_max_f32 v32, v12, v13
    v_max3_f32 v32, v14, v15, v32
    v_sub_f32 v12, v12, v32
    v_sub_f32 v13, v13, v32
    v_sub_f32 v14, v14, v32
    v_sub_f32 v15, v15, v32
    v_exp_f32 v12, v12
    v_exp_f32 v13, v13
    v_exp_f32 v14, v14
    v_exp_f32 v15, v15
    v_add_f32 v32, v12, v13
    v_add_f32 v33, v14, v15
    v_add_f32 v32, v32, v33
    v_rcp_f32 v32, v32
    v_pk_mul_f32 v[16:17], v[16:17], v[12:13] op_sel_hi:[1,0]
    v_pk_mul_f32 v[18:19], v[18:19], v[12:13] op_sel_hi:[1,0]
    v_pk_fma_f32 v[16:17], v[20:21], v[12:13], v[16:17] op_sel:[0,1,0] op_sel_hi:[1,1,1]
    v_pk_fma_f32 v[18:19], v[22:23], v[12:13], v[18:19] op_sel:[0,1,0] op_sel_hi:[1,1,1]
    v_pk_fma_f32 v[16:17], v[24:25], v[14:15], v[16:17] op_sel_hi:[1,0,1]
    v_pk_fma_f32 v[18:19], v[26:27], v[14:15], v[18:19] op_sel_hi:[1,0,1]
    v_pk_fma_f32 v[16:17], v[28:29], v[14:15], v[16:17] op_sel:[0,1,0] op_sel_hi:[1,1,1]
    v_pk_fma_f32 v[18:19], v[30:31], v[14:15], v[18:19] op_sel:[0,1,0] op_sel_hi:[1,1,1]
    v_pk_mul_f32 v[16:17], v[16:17], v[32:33] op_sel_hi:[1,0]
    v_pk_mul_f32 v[18:19], v[18:19], v[32:33] op_sel_hi:[1,0]
    v_cvt_pk_bf16_f32 v34, v16, v17
    v_cvt_pk_bf16_f32 v35, v18, v19
    ds_write_b64 v63, v[34:35]
LpA2:
    s_waitcnt lgkmcnt(0)
    s_barrier
    ds_read_b128 v[12:15], v62 offset:0
    ds_read_b128 v[16:19], v62 offset:64
    ds_read_b128 v[20:23], v62 offset:128
    ds_read_b128 v[24:27], v62 offset:192
    s_setpc_b64 s[70:71]
Loproj:
    s_waitcnt lgkmcnt(3)
    v_mfma_f32_16x16x32_bf16 v[28:31], v[12:15], v[36:39], 0
    ds_read_b64_tr_b16 v[36:37], v61 offset:8192
    ds_read_b64_tr_b16 v[38:39], v61 offset:8704
    v_mfma_f32_16x16x32_bf16 v[32:35], v[12:15], v[40:43], 0
    ds_read_b128 v[12:15], v62 offset:256
    ds_read_b64_tr_b16 v[40:41], v60 offset:12288
    ds_read_b64_tr_b16 v[42:43], v60 offset:12800
    s_waitcnt lgkmcnt(7)
    v_mfma_f32_16x16x32_bf16 v[28:31], v[16:19], v[44:47], v[28:31]
    ds_read_b64_tr_b16 v[44:45], v61 offset:12288
    ds_read_b64_tr_b16 v[46:47], v61 offset:12800
    v_mfma_f32_16x16x32_bf16 v[32:35], v[16:19], v[48:51], v[32:35]
    ds_read_b128 v[16:19], v62 offset:320
    ds_read_b64_tr_b16 v[48:49], v60 offset:16384
    ds_read_b64_tr_b16 v[50:51], v60 offset:16896
    s_waitcnt lgkmcnt(11)
    v_mfma_f32_16x16x32_bf16 v[28:31], v[20:23], v[52:55], v[28:31]
    ds_read_b64_tr_b16 v[52:53], v61 offset:16384
    ds_read_b64_tr_b16 v[54:55], v61 offset:16896
    s_waitcnt lgkmcnt(10)
    v_mfma_f32_16x16x32_bf16 v[32:35], v[20:23], v[36:39], v[32:35]
    ds_read_b128 v[20:23], v62 offset:384
    ds_read_b64_tr_b16 v[36:37], v60 offset:20480
    ds_read_b64_tr_b16 v[38:39], v60 offset:20992
    s_waitcnt lgkmcnt(10)
    v_mfma_f32_16x16x32_bf16 v[28:31], v[24:27], v[40:43], v[28:31]
    ds_read_b64_tr_b16 v[40:41], v61 offset:20480
    ds_read_b64_tr_b16 v[42:43], v61 offset:20992
    s_waitcnt lgkmcnt(10)
    v_mfma_f32_16x16x32_bf16 v[32:35], v[24:27], v[44:47], v[32:35]
    ds_read_b128 v[24:27], v62 offset:448
    ds_read_b64_tr_b16 v[44:45], v60 offset:24576
    ds_read_b64_tr_b16 v[46:47], v60 offset:25088
    s_waitcnt lgkmcnt(10)
    v_mfma_f32_16x16x32_bf16 v[28:31], v[12:15], v[48:51], v[28:31]
    ds_read_b64_tr_b16 v[48:49], v61 offset:24576
    ds_read_b64_tr_b16 v[50:51], v61 offset:25088
    s_waitcnt lgkmcnt(10)
    v_mfma_f32_16x16x32_bf16 v[32:35], v[12:15], v[52:55], v[32:35]
    ds_read_b64_tr_b16 v[52:53], v60 offset:28672
    ds_read_b64_tr_b16 v[54:55], v60 offset:29184
    s_waitcnt lgkmcnt(9)
    v_mfma_f32_16x16x32_bf16 v[28:31], v[16:19], v[36:39], v[28:31]
    ds_read_b64_tr_b16 v[36:37], v61 offset:28672
    ds_read_b64_tr_b16 v[38:39], v61 offset:29184
    s_waitcnt lgkmcnt(9)
    v_mfma_f32_16x16x32_bf16 v[32:35], v[16:19], v[40:43], v[32:35]
    s_waitcnt lgkmcnt(6)
    v_mfma_f32_16x16x32_bf16 v[28:31], v[20:23], v[44:47], v[28:31]
    s_waitcnt lgkmcnt(4)
    v_mfma_f32_16x16x32_bf16 v[32:35], v[20:23], v[48:51], v[32:35]
    s_waitcnt lgkmcnt(2)
    v_mfma_f32_16x16x32_bf16 v[28:31], v[24:27], v[52:55], v[28:31]
    s_waitcnt lgkmcnt(0)
    v_mfma_f32_16x16x32_bf16 v[32:35], v[24:27], v[36:39], v[32:35]
    s_mul_i32 s60, s56, 48
    s_add_u32 s60, s60, s55
    s_lshl_b32 s60, s60, 1
    s_add_u32 s60, s60, s75
    s_lshl_b32 s60, s60, 7
    s_mul_i32 s61, s76, 122880
    s_add_u32 s60, s60, s61
    s_add_u32 s60, s60, 200704
    s_lshr_b32 s76, s5, 1
    v_and_or_b32 v12, v28, -2, s76
    v_and_or_b32 v13, v32, -2, s76
    s_nop 0
    v_mov_b32_dpp v14, v12 row_ror:8 row_mask:0xf bank_mask:0xf
    v_mov_b32_dpp v15, v13 row_ror:8 row_mask:0xf bank_mask:0xf
    s_mov_b64 exec, 0x00ff00ff
    buffer_store_dwordx4 v[12:15], v64, s[40:43], s60 offen sc1
    s_mov_b64 exec, -1
    s_nop 0
    s_setpc_b64 s[70:71]
LpollB:
    v_lshrrev_b32 v64, 8, v0
    v_bfe_u32 v65, v0, 6, 2
    v_lshlrev_b32 v60, 12, v64
    v_lshl_or_b32 v60, v65, 9, v60
    v_and_b32 v66, 1, v64
    v_lshl_or_b32 v65, v66, 2, v65
    v_lshl_or_b32 v60, v65, 5, v60
    v_bfe_u32 v65, v0, 4, 2
    v_lshl_or_b32 v60, v65, 3, v60
    s_lshl_b32 s65, s4, 7
    v_xor_b32 v60, s65, v60
    v_xor_b32 v61, 32, v60
    v_xor_b32 v62, 64, v60
    v_xor_b32 v63, 96, v60
    v_mul_u32_u24 v66, 27648, v64
    v_and_b32 v67, 0xf0, v0
    v_add_u32 v66, v66, v67
    v_bfe_u32 v67, v0, 6, 2
    v_min_u32 v67, 2, v67
    v_lshlrev_b32 v67, 8, v67
    v_lshl_add_u32 v64, v64, 4, v67
    v_add_u32 v64, 161792, v64
    v_bfe_u32 v65, v0, 7, 1
    v_lshrrev_b32 v67, 8, v0
    v_lshl_or_b32 v65, v65, 2, v67
    v_bfe_u32 v67, v0, 4, 3
    v_lshl_or_b32 v65, v65, 3, v67
    s_lshl_b32 s65, s75, 8
    s_lshr_b32 s66, s4, 1
    s_lshl_b32 s66, s66, 7
    s_add_u32 s65, s65, s66
    s_add_u32 s65, s65, 161792
    v_lshl_add_u32 v65, v65, 1, s65
    v_lshrrev_b32 v67, 9, v0
    v_bfe_u32 v59, v0, 4, 1
    v_lshlrev_b32 v67, 2, v67
    v_lshl_or_b32 v67, v59, 3, v67
    s_mul_i32 s60, s78, 6144
    s_mul_i32 s61, s76, 122880
    s_add_u32 s60, s60, s61
    s_add_u32 s60, s60, 200704
    s_add_u32 s62, s60, 4096
    s_lshr_b32 s76, s5, 1
    s_sub_u32 s77, 0, s76
    s_barrier
    ds_read_b64_tr_b16 v[36:37], v60 offset:0
    ds_read_b64_tr_b16 v[38:39], v60 offset:2048
    ds_read_b64_tr_b16 v[40:41], v61 offset:0
    ds_read_b64_tr_b16 v[42:43], v61 offset:2048
    ds_read_b64_tr_b16 v[44:45], v62 offset:0
    ds_read_b64_tr_b16 v[46:47], v62 offset:2048
    ds_read_b64_tr_b16 v[48:49], v63 offset:0
    ds_read_b64_tr_b16 v[50:51], v63 offset:2048
    ds_read_b64_tr_b16 v[52:53], v60 offset:16384
    ds_read_b64_tr_b16 v[54:55], v60 offset:18432
    s_sleep 10
    s_mov_b32 s59, 262144
Lp_49:
    buffer_load_dwordx4 v[12:15], v0, s[40:43], s60 offen offset:0 sc1
    buffer_load_dwordx4 v[16:19], v0, s[40:43], s60 offen offset:1024 sc1
    buffer_load_dwordx4 v[20:23], v0, s[40:43], s60 offen offset:2048 sc1
    buffer_load_dwordx4 v[24:27], v0, s[40:43], s60 offen offset:3072 sc1
    buffer_load_dwordx4 v[28:31], v0, s[40:43], s62 offen offset:0 sc1
    buffer_load_dwordx4 v[32:35], v0, s[40:43], s62 offen offset:1024 sc1
    s_waitcnt vmcnt(5)
    v_bitop3_b32 v10, v12, v13, s77 bitop3:0x7e
    v_bitop3_b32 v11, v14, v15, s77 bitop3:0x7e
    v_or_b32 v10, v10, v11
    s_waitcnt vmcnt(4)
    v_bitop3_b32 v11, v16, v17, s77 bitop3:0x7e
    v_bitop3_b32 v59, v18, v19, s77 bitop3:0x7e
    v_or3_b32 v10, v10, v11, v59
    s_waitcnt vmcnt(3)
    v_bitop3_b32 v11, v20, v21, s77 bitop3:0x7e
    v_bitop3_b32 v59, v22, v23, s77 bitop3:0x7e
    v_or3_b32 v10, v10, v11, v59
    s_waitcnt vmcnt(2)
    v_bitop3_b32 v11, v24, v25, s77 bitop3:0x7e
    v_bitop3_b32 v59, v26, v27, s77 bitop3:0x7e
    v_or3_b32 v10, v10, v11, v59
    s_waitcnt vmcnt(1)
    v_bitop3_b32 v11, v28, v29, s77 bitop3:0x7e
    v_bitop3_b32 v59, v30, v31, s77 bitop3:0x7e
    v_or3_b32 v10, v10, v11, v59
    s_waitcnt vmcnt(0)
    v_bitop3_b32 v11, v32, v33, s77 bitop3:0x7e
    v_bitop3_b32 v59, v34, v35, s77 bitop3:0x7e
    v_or3_b32 v10, v10, v11, v59
    v_and_b32 v10, 1, v10
    v_cmp_ne_u32 vcc, 0, v10
    s_sub_u32 s59, s59, 1
    s_cbranch_scc1 Lpx_50
    s_cbranch_vccnz Lp_49
Lpx_50:
    v_pk_add_f32 v[12:13], v[12:13], v[16:17]
    v_pk_add_f32 v[14:15], v[14:15], v[18:19]
    v_pk_add_f32 v[20:21], v[20:21], v[24:25]
    v_pk_add_f32 v[22:23], v[22:23], v[26:27]
    v_pk_add_f32 v[28:29], v[28:29], v[32:33]
    v_pk_add_f32 v[30:31], v[30:31], v[34:35]
    v_pk_add_f32 v[12:13], v[12:13], v[20:21]
    v_pk_add_f32 v[14:15], v[14:15], v[22:23]
    v_pk_add_f32 v[12:13], v[12:13], v[28:29]
    v_pk_add_f32 v[14:15], v[14:15], v[30:31]
    s_nop 0
    v_permlane32_swap_b32 v12, v13
    v_permlane32_swap_b32 v14, v15
    v_add_f32 v12, v12, v13
    v_add_f32 v14, v14, v15
    s_nop 1
    v_permlane16_swap_b32 v12, v14
    v_add_f32 v12, v12, v14
    v_cvt_pk_bf16_f32 v12, v12, v12
    v_and_b32 v12, 0xffff0000, v12
    v_add_f32 v12, v12, v8
    v_cvt_pk_bf16_f32 v12, v12, v12
    s_cmp_lg_u32 s5, 3
    s_cbranch_scc1 LpB1
    s_mul_i32 s60, s75, 1024
    s_lshl_b32 s61, s79, 8
    s_add_u32 s60, s60, s61
    v_subrev_u32 v65, 161792, v65
    buffer_store_short v12, v65, s[44:47], s60 offen
    s_nop 1
    s_setpc_b64 s[70:71]
LpB1:
    ds_write_b16 v65, v12
    v_and_b32 v8, 0xffff0000, v12
    v_and_b32 v56, 0xffff0000, v12
    s_add_u32 s76, s5, 1
    s_and_b32 s76, s76, 1
    s_waitcnt lgkmcnt(0)
    s_barrier
    s_setpc_b64 s[70:71]
Lqproj:
    ds_read_b128 v[28:31], v64 offset:0
    ds_read_b128 v[32:35], v64 offset:64
    s_waitcnt lgkmcnt(1)
    v_mfma_f32_16x16x32_bf16 v[12:15], v[28:31], v[36:39], 0
    ds_read_b64_tr_b16 v[36:37], v61 offset:16384
    ds_read_b64_tr_b16 v[38:39], v61 offset:18432
    v_mul_f32 v57, v56, v56
    v_mfma_f32_16x16x32_bf16 v[16:19], v[28:31], v[40:43], 0
    ds_read_b64_tr_b16 v[40:41], v62 offset:16384
    ds_read_b64_tr_b16 v[42:43], v62 offset:18432
    v_permlane32_swap_b32 v56, v57
    v_mfma_f32_16x16x32_bf16 v[20:23], v[28:31], v[44:47], 0
    ds_read_b64_tr_b16 v[44:45], v63 offset:16384
    ds_read_b64_tr_b16 v[46:47], v63 offset:18432
    v_add_f32 v56, v56, v57
    v_mfma_f32_16x16x32_bf16 v[24:27], v[28:31], v[48:51], 0
    ds_read_b128 v[28:31], v64 offset:128
    ds_read_b64_tr_b16 v[48:49], v60 offset:32768
    ds_read_b64_tr_b16 v[50:51], v60 offset:34816
    v_add_f32_dpp v56, v56, v56 row_ror:8 row_mask:0xf bank_mask:0xf
    s_waitcnt lgkmcnt(9)
    v_mfma_f32_16x16x32_bf16 v[12:15], v[32:35], v[52:55], v[12:15]
    ds_read_b64_tr_b16 v[52:53], v61 offset:32768
    ds_read_b64_tr_b16 v[54:55], v61 offset:34816
    v_add_f32_dpp v56, v56, v56 row_ror:4 row_mask:0xf bank_mask:0xf
    s_waitcnt lgkmcnt(9)
    v_mfma_f32_16x16x32_bf16 v[16:19], v[32:35], v[36:39], v[16:19]
    ds_read_b64_tr_b16 v[36:37], v62 offset:32768
    ds_read_b64_tr_b16 v[38:39], v62 offset:34816
    v_add_f32_dpp v56, v56, v56 row_ror:2 row_mask:0xf bank_mask:0xf
    s_waitcnt lgkmcnt(9)
    v_mfma_f32_16x16x32_bf16 v[20:23], v[32:35], v[40:43], v[20:23]
    ds_read_b64_tr_b16 v[40:41], v63 offset:32768
    ds_read_b64_tr_b16 v[42:43], v63 offset:34816
    v_add_f32_dpp v56, v56, v56 row_ror:1 row_mask:0xf bank_mask:0xf
    s_waitcnt lgkmcnt(9)
    v_mfma_f32_16x16x32_bf16 v[24:27], v[32:35], v[44:47], v[24:27]
    ds_read_b128 v[32:35], v64 offset:192
    ds_read_b64_tr_b16 v[44:45], v60 offset:49152
    ds_read_b64_tr_b16 v[46:47], v60 offset:51200
    v_mov_b32 v57, v56
    s_waitcnt lgkmcnt(11)
    s_waitcnt lgkmcnt(9)
    v_mfma_f32_16x16x32_bf16 v[12:15], v[28:31], v[48:51], v[12:15]
    ds_read_b64_tr_b16 v[48:49], v61 offset:49152
    ds_read_b64_tr_b16 v[50:51], v61 offset:51200
    v_permlane16_swap_b32 v56, v57
    s_waitcnt lgkmcnt(9)
    v_mfma_f32_16x16x32_bf16 v[16:19], v[28:31], v[52:55], v[16:19]
    ds_read_b64_tr_b16 v[52:53], v62 offset:49152
    ds_read_b64_tr_b16 v[54:55], v62 offset:51200
    v_add_f32 v56, v56, v57
    s_waitcnt lgkmcnt(9)
    v_mfma_f32_16x16x32_bf16 v[20:23], v[28:31], v[36:39], v[20:23]
    ds_read_b64_tr_b16 v[36:37], v63 offset:49152
    ds_read_b64_tr_b16 v[38:39], v63 offset:51200
    v_and_or_b32 v56, v56, -2, s76
    s_waitcnt lgkmcnt(9)
    v_mfma_f32_16x16x32_bf16 v[24:27], v[28:31], v[40:43], v[24:27]
    s_waitcnt lgkmcnt(8)
    s_waitcnt lgkmcnt(6)
    v_mfma_f32_16x16x32_bf16 v[12:15], v[32:35], v[44:47], v[12:15]
    s_waitcnt lgkmcnt(4)
    v_mfma_f32_16x16x32_bf16 v[16:19], v[32:35], v[48:51], v[16:19]
    s_waitcnt lgkmcnt(2)
    v_mfma_f32_16x16x32_bf16 v[20:23], v[32:35], v[52:55], v[20:23]
    s_waitcnt lgkmcnt(0)
    v_mfma_f32_16x16x32_bf16 v[24:27], v[32:35], v[36:39], v[24:27]
    s_mul_i32 s60, s79, 82944
    s_add_u32 s60, s60, 720896
    s_mul_i32 s61, s75, 27648
    s_add_u32 s61, s61, s60
    s_lshl_b32 s62, s55, 7
    s_add_u32 s61, s61, s62
    s_lshr_b32 s62, s4, 1
    s_lshl_b32 s62, s62, 4
    s_add_u32 s61, s61, s62
    s_add_u32 s61, s61, 24576
    s_lshl_b32 s62, s55, 2
    s_add_u32 s62, s62, s4
    s_lshl_b32 s62, s62, 8
    s_add_u32 s60, s60, s62
    v_and_or_b32 v12, v12, -2, s76
    v_and_or_b32 v13, v16, -2, s76
    v_and_or_b32 v14, v20, -2, s76
    v_and_or_b32 v15, v24, -2, s76
    s_nop 1
    s_cmp_eq_u32 s6, 0
    s_cbranch_scc1 Lg_51
    s_mov_b32 exec_lo, -1
    s_mov_b32 exec_hi, 0xffff
    buffer_store_dwordx4 v[12:15], v66, s[40:43], s60 offen
    s_mov_b32 exec_lo, 3
    s_mov_b32 exec_hi, 3
    buffer_store_dword v56, v67, s[40:43], s61 offen
    s_branch Lgx_52
Lg_51:
    s_mov_b32 exec_lo, -1
    s_mov_b32 exec_hi, 0xffff
    buffer_store_dwordx4 v[12:15], v66, s[40:43], s60 offen sc1
    s_mov_b32 exec_lo, 3
    s_mov_b32 exec_hi, 3
    buffer_store_dword v56, v67, s[40:43], s61 offen sc1
Lgx_52:
    s_mov_b64 exec, -1
    s_nop 0
    s_setpc_b64 s[72:73]
Lcissue:
    s_add_u32 s76, s5, 1
    s_and_b32 s76, s76, 1
    s_sub_u32 s77, 0, s76
    s_mul_i32 s60, s52, 768
    s_add_u32 s61, s60, 55296
    v_min_u32 v57, 0x2f0, v0
    v_add_u32 v57, s61, v57
    v_add_u32 v58, s60, v0
    s_mul_i32 s60, s52, 3
    s_lshr_b32 s60, s60, 2
    s_lshl_b32 s60, s60, 7
    s_add_u32 s60, s60, 24576
    v_and_b32 v59, 16, v0
    v_add_u32 v59, s60, v59
    v_cmp_gt_u32 vcc, 0x300, v0
    s_mul_i32 s60, s53, 27648
    s_nop 0
    v_cndmask_b32 v58, v59, v58, vcc
    v_add_u32 v58, s60, v58
    s_mov_b32 s60, 720896
    buffer_load_dwordx4 v[12:15], v58, s[40:43], s60 offen sc1
    buffer_load_dwordx4 v[32:35], v57, s[40:43], s60 offen sc1
    s_mov_b32 s60, 803840
    buffer_load_dwordx4 v[16:19], v58, s[40:43], s60 offen sc1
    buffer_load_dwordx4 v[36:39], v57, s[40:43], s60 offen sc1
    s_mov_b32 s60, 886784
    buffer_load_dwordx4 v[20:23], v58, s[40:43], s60 offen sc1
    buffer_load_dwordx4 v[40:43], v57, s[40:43], s60 offen sc1
    s_mov_b32 s60, 969728
    buffer_load_dwordx4 v[24:27], v58, s[40:43], s60 offen sc1
    buffer_load_dwordx4 v[44:47], v57, s[40:43], s60 offen sc1
    s_mov_b32 s60, 1052672
    buffer_load_dwordx4 v[28:31], v58, s[40:43], s60 offen sc1
    buffer_load_dwordx4 v[48:51], v57, s[40:43], s60 offen sc1
    v_lshrrev_b32 v56, 8, v0
    v_bfe_u32 v55, v0, 4, 4
    v_lshl_add_u32 v56, v56, 6, v55
    v_lshlrev_b32 v56, 1, v56
    v_add_u32 v56, 162560, v56
    s_mov_b32 s59, 262144
    s_nop 0
    s_setpc_b64 s[70:71]
Lcretry:
    s_mov_b32 s60, 720896
    buffer_load_dwordx4 v[12:15], v58, s[40:43], s60 offen sc1
    buffer_load_dwordx4 v[32:35], v57, s[40:43], s60 offen sc1
    s_mov_b32 s60, 803840
    buffer_load_dwordx4 v[16:19], v58, s[40:43], s60 offen sc1
    buffer_load_dwordx4 v[36:39], v57, s[40:43], s60 offen sc1
    s_mov_b32 s60, 886784
    buffer_load_dwordx4 v[20:23], v58, s[40:43], s60 offen sc1
    buffer_load_dwordx4 v[40:43], v57, s[40:43], s60 offen sc1
    s_mov_b32 s60, 969728
    buffer_load_dwordx4 v[24:27], v58, s[40:43], s60 offen sc1
    buffer_load_dwordx4 v[44:47], v57, s[40:43], s60 offen sc1
    s_mov_b32 s60, 1052672
    buffer_load_dwordx4 v[28:31], v58, s[40:43], s60 offen sc1
    buffer_load_dwordx4 v[48:51], v57, s[40:43], s60 offen sc1
    s_waitcnt vmcnt(0)
Lccheck:
    v_bitop3_b32 v11, v12, v13, s77 bitop3:0x7e
    v_bitop3_b32 v59, v14, v15, s77 bitop3:0x7e
    v_or3_b32 v10, v11, v11, v59
    v_bitop3_b32 v11, v16, v17, s77 bitop3:0x7e
    v_bitop3_b32 v59, v18, v19, s77 bitop3:0x7e
    v_or3_b32 v10, v10, v11, v59
    v_bitop3_b32 v11, v20, v21, s77 bitop3:0x7e
    v_bitop3_b32 v59, v22, v23, s77 bitop3:0x7e
    v_or3_b32 v10, v10, v11, v59
    v_bitop3_b32 v11, v24, v25, s77 bitop3:0x7e
    v_bitop3_b32 v59, v26, v27, s77 bitop3:0x7e
    v_or3_b32 v10, v10, v11, v59
    v_bitop3_b32 v11, v28, v29, s77 bitop3:0x7e
    v_bitop3_b32 v59, v30, v31, s77 bitop3:0x7e
    v_or3_b32 v10, v10, v11, v59
    v_bitop3_b32 v11, v32, v33, s77 bitop3:0x7e
    v_bitop3_b32 v59, v34, v35, s77 bitop3:0x7e
    v_or3_b32 v10, v10, v11, v59
    v_bitop3_b32 v11, v36, v37, s77 bitop3:0x7e
    v_bitop3_b32 v59, v38, v39, s77 bitop3:0x7e
    v_or3_b32 v10, v10, v11, v59
    v_bitop3_b32 v11, v40, v41, s77 bitop3:0x7e
    v_bitop3_b32 v59, v42, v43, s77 bitop3:0x7e
    v_or3_b32 v10, v10, v11, v59
    v_bitop3_b32 v11, v44, v45, s77 bitop3:0x7e
    v_bitop3_b32 v59, v46, v47, s77 bitop3:0x7e
    v_or3_b32 v10, v10, v11, v59
    v_bitop3_b32 v11, v48, v49, s77 bitop3:0x7e
    v_bitop3_b32 v59, v50, v51, s77 bitop3:0x7e
    v_or3_b32 v10, v10, v11, v59
    v_and_b32 v10, 1, v10
    v_cmp_ne_u32 vcc, 0, v10
    s_sub_u32 s59, s59, 1
    s_cbranch_scc1 Lcok
    s_cbranch_vccz Lcok
    s_cmp_eq_u32 s35, 0
    s_cbranch_scc1 Lcretry
    s_setpc_b64 s[72:73]
Lcok:
    s_mov_b32 s81, 1
    v_pk_add_f32 v[12:13], v[12:13], v[16:17]
    v_pk_add_f32 v[14:15], v[14:15], v[18:19]
    v_pk_add_f32 v[20:21], v[20:21], v[24:25]
    v_pk_add_f32 v[22:23], v[22:23], v[26:27]
    v_pk_add_f32 v[12:13], v[12:13], v[28:29]
    v_pk_add_f32 v[14:15], v[14:15], v[30:31]
    v_pk_add_f32 v[12:13], v[12:13], v[20:21]
    v_pk_add_f32 v[14:15], v[14:15], v[22:23]
    v_pk_add_f32 v[32:33], v[32:33], v[36:37]
    v_pk_add_f32 v[34:35], v[34:35], v[38:39]
    v_pk_add_f32 v[40:41], v[40:41], v[44:45]
    v_pk_add_f32 v[42:43], v[42:43], v[46:47]
    v_pk_add_f32 v[32:33], v[32:33], v[48:49]
    v_pk_add_f32 v[34:35], v[34:35], v[50:51]
    v_pk_add_f32 v[32:33], v[32:33], v[40:41]
    v_pk_add_f32 v[34:35], v[34:35], v[42:43]
    v_add_f32_dpp v16, v12, v12 quad_perm:[1,0,3,2] row_mask:0xf bank_mask:0xf
    v_add_f32_dpp v17, v13, v13 quad_perm:[1,0,3,2] row_mask:0xf bank_mask:0xf
    v_mov_b32 v19, 0x3acccccd
    v_readlane_b32 s60, v16, 48
    v_readlane_b32 s61, v17, 48
    s_nop 0
    v_mul_f32 v17, s60, v19
    v_mul_f32 v18, s61, v19
    v_fma_f32 v18, -v17, v17, v18
    v_max_f32 v18, 0, v18
    v_add_f32 v18, 0x3727c5ac, v18
    v_rsq_f32 v18, v18
    v_fma_f32 v12, -v17, v32, v12
    v_fma_f32 v13, -v17, v33, v13
    v_fma_f32 v14, -v17, v34, v14
    v_fma_f32 v15, -v17, v35, v15
    v_pk_mul_f32 v[12:13], v[12:13], v[18:19] op_sel_hi:[1,0]
    v_pk_mul_f32 v[14:15], v[14:15], v[18:19] op_sel_hi:[1,0]
    v_cvt_pk_bf16_f32 v12, v12, v13
    v_cvt_pk_bf16_f32 v14, v14, v15
    s_mov_b32 exec_lo, -1
    s_mov_b32 exec_hi, 0xffff
    ds_write_b16 v56, v12
    ds_write_b16_d16_hi v56, v12 offset:32
    ds_write_b16 v56, v14 offset:64
    ds_write_b16_d16_hi v56, v14 offset:96
    s_mov_b64 exec, -1
    s_waitcnt lgkmcnt(0)
    s_setpc_b64 s[72:73]
.section .rodata,"a"
.p2align 6
.amdhsa_kernel interleave_layers__gqa_block_cached__sliding_block_cached__decode_kernel
  .amdhsa_next_free_vgpr 512
  .amdhsa_next_free_sgpr 102
  .amdhsa_accum_offset 256
  .amdhsa_group_segment_fixed_size 0
  .amdhsa_kernarg_size 104
  .amdhsa_user_sgpr_count 2
  .amdhsa_user_sgpr_kernarg_segment_ptr 1
  .amdhsa_system_sgpr_workgroup_id_x 1
.end_amdhsa_kernel
```
